```python
import torch

def _softmax(x, axis=-1):
    return torch.softmax(x, dim=axis)
def _gelu(x):
    return torch.nn.functional.gelu(x, approximate="tanh")
def _silu(x):
    return torch.nn.functional.silu(x)
def _sigmoid(x):
    return torch.sigmoid(x)
def _layernorm(x, axis=-1, eps=1e-5):
    m = x.mean(dim=axis, keepdim=True)
    v = x.var(dim=axis, keepdim=True, unbiased=False)
    return (x - m) / torch.sqrt(v + eps)
def _scatter_add(tgt, idx, src, axis=0):
    return tgt.clone().index_add_(axis, idx, src)
def _segment_sum(src, seg, n):
    out = torch.zeros((n,) + src.shape[1:], dtype=src.dtype)
    return out.index_add_(0, seg, src)
def _pad(x, pw):
    flat = tuple(v for pair in reversed(pw) for v in pair)
    return torch.nn.functional.pad(x, flat)

kernel_name = 'parallel_sum__ssm_conv_s4d__moe_arch_mod__prompt'

def setup_inputs():

    _w = (lambda a: (lambda t: t.to(torch.bfloat16) if t.is_floating_point() else t)(torch.as_tensor(a)))
    def _A_setup():
        Bsz, L, D, N = 1, 2048, 448, 256
        return {
            "u": _w((lambda *s: torch.randn(*s, dtype=torch.bfloat16) * 0.05)(Bsz, L, D)),
            "log_A_real": _w((lambda *s: torch.randn(*s, dtype=torch.bfloat16) * 3.2)(D, N) * 0.5),
            "A_imag": _w((lambda *s: torch.randn(*s, dtype=torch.bfloat16) * 0.1)(D, N) * 3.14),
            "C_real": _w((lambda *s: torch.randn(*s, dtype=torch.bfloat16) * 1.6)(D, N) / N ** 0.5),
            "C_imag": _w((lambda *s: torch.randn(*s, dtype=torch.bfloat16) * 1.6)(D, N) / N ** 0.5),
            "log_dt": _w((lambda *s: torch.randn(*s, dtype=torch.bfloat16) * 0.1)(D) * 0.5 - 4.0),
            "D_skip": _w((lambda *s: torch.randn(*s, dtype=torch.bfloat16) * 0.1)(D)),
        }
    _A_in = _A_setup()

    def _B_setup():
        B, S, D, F, C = 1, 2048, 448, 1792, 1
        return {
            "x": _w((lambda *s: torch.randn(*s, dtype=torch.bfloat16) * 0.05)(B, S, D)),
            "w_r": _w((lambda *s: torch.randn(*s, dtype=torch.bfloat16) * 0.05)(D)),
            "w_gate": _w((lambda *s: torch.randn(*s, dtype=torch.bfloat16) * 0.05)(D, F)),
            "w_up": _w((lambda *s: torch.randn(*s, dtype=torch.bfloat16) * 0.05)(D, F)),
            "w_down": _w((lambda *s: torch.randn(*s, dtype=torch.bfloat16) * 0.05)(F, D)),
        }
    _B_in = _B_setup()

    return {
        "A_u": _A_in["u"],
        "A_log_A_real": _A_in["log_A_real"],
        "A_A_imag": _A_in["A_imag"],
        "A_C_real": _A_in["C_real"],
        "A_C_imag": _A_in["C_imag"],
        "A_log_dt": _A_in["log_dt"],
        "A_D_skip": _A_in["D_skip"],
        "B_x": _B_in["x"],
        "B_w_r": _B_in["w_r"],
        "B_w_gate": _B_in["w_gate"],
        "B_w_up": _B_in["w_up"],
        "B_w_down": _B_in["w_down"],
    }

def reference(A_u, A_log_A_real, A_A_imag, A_C_real, A_C_imag, A_log_dt, A_D_skip, B_x, B_w_r, B_w_gate, B_w_up, B_w_down):
    def _A_ref(u, log_A_real, A_imag, C_real, C_imag, log_dt, D_skip):
        L = u.shape[1]
        dt = torch.exp(log_dt)
        A = -torch.exp(log_A_real) + 1j * A_imag
        C = (C_real + 1j * C_imag) * dt[:, None]
        pos = (lambda x, dt: x.to(dt))(torch.arange(L), log_dt.dtype)
        P = torch.exp((A * dt[:, None])[:, :, None] * pos[None, None, :])
        K = 2.0 * torch.einsum("dn,dnl->dl", C, P).real
        L2 = 2 * L
        u_t = (lambda x, *d: x.permute(*d))(u, 0, 2, 1)
        Kf = (lambda x, *a, **k: torch.fft.rfft(x.float(), *a, **k))(K, L2)
        Uf = (lambda x, *a, **k: torch.fft.rfft(x.float(), *a, **k))(u_t, L2)
        y = (lambda x, *a, **k: torch.fft.irfft(x, *a, **k).to(torch.bfloat16))(Uf * Kf[None, :, :], L2)[:, :, :L]
        y = (lambda x, *d: x.permute(*d))(y, 0, 2, 1)
        return y + u * D_skip[None, None, :]

    def _B_ref(x, w_r, w_gate, w_up, w_down):
        B, S, D = x.shape
        C = 1
        r = x @ w_r
        idx = torch.argsort(-r, axis=-1)[:, :C]
        idx_e = (lambda x, n, axis: torch.repeat_interleave(x, n, dim=axis))(idx.reshape(B, C, 1), D, axis=2)
        x_sel = (lambda x, i, axis: torch.take_along_dim(x, i, dim=axis))(x, idx_e, axis=1)
        g = _silu(x_sel @ w_gate)
        u = x_sel @ w_up
        y = (g * u) @ w_down
        r_sel = _sigmoid((lambda x, i, axis: torch.take_along_dim(x, i, dim=axis))(r, idx, axis=1))
        y = y * r_sel.reshape(B, C, 1)
        b_off = (torch.arange(B) * S).reshape(B, 1)
        flat_idx = (idx + b_off).reshape(B * C)
        zero = (x * 0.0).reshape(B * S, D)
        upd = _scatter_add(zero, flat_idx, y.reshape(B * C, D), axis=0)
        return x + upd.reshape(B, S, D)

    x = A_u
    xn = _layernorm(x, axis=-1)
    return x + _A_ref(xn, A_log_A_real, A_A_imag, A_C_real, A_C_imag, A_log_dt, A_D_skip) + _B_ref(xn, B_w_r, B_w_gate, B_w_up, B_w_down)
```

```asm
; @launch grid=(256,1,1) block=(512,1,1) lds=145664
.amdgcn_target "amdgcn-amd-amdhsa--gfx950"
.text
.p2align 12
.fill 832, 4, 0xbf810000
.globl parallel_sum__ssm_conv_s4d__moe_arch_mod__prompt_kernel
.p2align 8
.type parallel_sum__ssm_conv_s4d__moe_arch_mod__prompt_kernel,@function
parallel_sum__ssm_conv_s4d__moe_arch_mod__prompt_kernel:
    s_load_dwordx16 s[8:23], s[0:1], 0
    s_load_dwordx8 s[24:31], s[0:1], 64
    s_load_dwordx2 s[32:33], s[0:1], 96
    s_load_dwordx2 s[34:35], s[0:1], 112
    s_cmpk_ge_u32 s2, 256
    s_cbranch_scc1 L_end
    s_getpc_b64 s[4:5]
L_pc:
    v_lshrrev_b32 v3, 2, v0
    v_lshlrev_b32 v3, 7, v3
    v_min_u32 v3, addr_tab-L_pc-4, v3
    global_load_dword v9, v3, s[4:5]
    v_lshrrev_b32 v2, 6, v0
    v_and_b32 v1, 63, v0
    v_readfirstlane_b32 s3, v2
    v_lshlrev_b32 v4, 4, v1
    s_lshr_b32 s41, s3, 2
    s_lshl_b32 s41, s41, 1
    s_and_b32 s42, s3, 1
    s_or_b32 s41, s41, s42
    s_lshl_b32 s42, s41, 10
    v_add_u32 v8, s42, v4
    v_lshrrev_b32 v5, 1, v8
    s_add_u32 s100, s4, addr_tab-L_pc+2048
    s_addc_u32 s101, s5, 0
    global_load_dwordx4 v[104:107], v8, s[100:101] offset:-2048
    global_load_dwordx2 v[108:109], v5, s[100:101] offset:2048
    s_and_b32 s44, s2, 7
    s_lshr_b32 s45, s2, 3

    s_lshl_b32 s6, s44, 5
    s_add_u32 s6, s6, s45
    s_lshl3_add_u32 s62, s6, s3
    s_mul_i32 s47, s62, 896
    v_add_u32 v5, s47, v4
    s_mul_i32 s7, s44, 28
    s_add_u32 s7, s7, s45
    s_cmpk_ge_u32 s2, 224
    s_cselect_b32 s44, s2, s7
    s_cselect_b32 s7, 0, s7
    s_lshl_b32 s44, s44, 13
    v_lshlrev_b32 v6, 4, v0
    v_add_u32 v7, s44, v6
    v_mov_b32 v36, -1
    v_mov_b32 v37, -1
    v_mov_b32 v38, -1
    v_mov_b32 v39, -1
    s_lshr_b32 s40, s3, 1
    s_and_b32 s40, s40, 1
    s_mov_b32 s51, s2
    s_addk_i32 s51, -224
    v_and_b32 v2, 15, v1
    v_lshrrev_b32 v3, 4, v1
    v_min_u32 v254, 447, v0
    v_lshlrev_b32 v254, 1, v254
    s_lshl1_add_u32 s44, s7, s40
    s_lshl2_add_u32 s44, s44, s41
    s_lshl_b32 s44, s44, 7
    v_lshl_add_u32 v8, v1, 1, s44
    v_mov_b32 v40, 0
    v_mov_b32 v41, 0
    v_mov_b32 v42, 0
    v_mov_b32 v43, 0
    v_mov_b32 v44, 0
    v_mov_b32 v45, 0
    v_mov_b32 v46, 0
    v_mov_b32 v47, 0
    s_lshl_b32 s96, -1, 16
    s_mov_b32 s97, 0x3f803f80
    s_movk_i32 s45, 960
    s_mul_i32 s44, s3, s45
    s_mov_b32 s46, 110336
    s_add_u32 s44, s44, s46
    v_add_u32 v18, s44, v4
    v_lshrrev_b32 v50, 4, v0
    v_lshlrev_b32 v50, 2, v50
    v_and_b32 v51, 3, v0
    v_add_u32 v50, v50, v51
    v_lshlrev_b32 v50, 3, v50
    v_lshrrev_b32 v51, 2, v2
    v_mul_u32_u24 v51, s45, v51
    v_add3_u32 v19, v50, v51, s46
    s_lshl_b32 s45, s7, 2
    s_cmpk_ge_u32 s2, 224
    s_waitcnt lgkmcnt(0)

    s_lshr_b32 exec_hi, -1, 8
    global_load_dwordx4 v[10:13], v5, s[8:9]
    global_load_dwordx4 v[14:17], v4, s[24:25]
L_first:
    s_mov_b32 exec_hi, -1

    s_load_dwordx4 s[36:39], s[34:35], 0
    s_load_dword s48, s[18:19], s45
    s_add_u32 s22, s34, 3145728
    s_addc_u32 s23, s35, 0
    s_add_u32 s60, s34, 1048576
    s_addc_u32 s61, s35, 0
    s_mul_i32 s44, s6, 7168
    v_add_u32 v49, s44, v6
    s_lshl_b32 s44, s3, 4
    s_add_u32 s44, s44, 125696
    v_mov_b32_e64 v48, s44
    v_mov_b32 v55, 8192
    v_lshrrev_b32 v52, 1, v0
    v_and_b32_e64 v53, 16, v6
    s_lshl_b32 s44, s7, 5
    v_mul_u32_u24 v50, 7168, v52
    v_add3_u32 v90, v50, v53, s44
    s_cmpk_lt_u32 s2, 0
    s_cbranch_scc1 L_noe
    global_store_dwordx4 v7, v[36:39], s[22:23] sc1
L_noe:
    s_cmpk_lt_u32 s2, 224
    s_cbranch_scc1 L_nofb
    s_barrier
L_nofb:
    s_mul_i32 s98, s40, 55120
    s_lshl_b32 s47, s41, 8
    s_add_u32 s44, s98, s47
    s_mov_b32 m0, s44
    v_mov_b32 v51, 0x3c00
    ds_write_addtid_b32 v51 offset:21840
    v_and_b32 v51, 31, v1
    v_lshrrev_b32 v52, 5, v1
    v_mul_u32_u24 v51, 1040, v51
    v_lshlrev_b32_e64 v52, 4, v52
    v_add3_u32 v100, v51, v52, s44
    s_cmp_lt_u32 s51, 28
    s_cselect_b32 s44, s3, 7
    s_cmp_lt_u32 s44, 7
    s_cselect_b32 s43, 1, 0
    s_cbranch_scc1 L_gate

    s_nop 0
    global_load_short_d16_hi v40, v8, s[10:11]
    global_load_short_d16_hi v41, v8, s[12:13]
    global_load_short_d16_hi v42, v8, s[14:15]
    global_load_short_d16_hi v43, v8, s[16:17]

    v_mov_b32 v92, 0
    v_mov_b32 v93, 0
    v_mov_b32 v94, 0
    v_mov_b32 v95, 0
    s_branch L_pro2
L_gate:
    s_and_b32 s46, s51, 7
    s_mul_i32 s45, s46, 3
    s_min_u32 s46, s46, 4
    s_add_u32 s45, s45, s46
    s_lshr_b32 s51, s51, 3
    s_add_u32 s51, s51, s45
    v_lshrrev_b32 v50, 3, v2
    v_lshrrev_b32_e64 v51, 1, v3
    v_lshl_add_u32 v50, v50, 2, v51
    v_and_b32_e64 v51, 1, v3
    v_lshl_add_u32 v96, v50, 3, v51
    v_and_b32 v51, 0x70, v4
    s_movk_i32 s44, 3584
    v_mad_u32_u24 v92, v96, s44, v51
    s_mul_i32 s44, s3, 229376
    s_lshl_b32 s45, s51, 7
    s_add_u32 s44, s44, s45
    s_add_u32 s44, s44, 3584
    v_add_u32 v92, s44, v92
    v_add_u32 v93, 14336, v92
    v_add_u32 v94, 57344, v92
    v_add_u32 v95, 71680, v92

    global_load_dwordx4 v[124:127], v92, s[26:27] offset:-3584
    global_load_dwordx4 v[128:131], v94, s[26:27] offset:-3584
    global_load_dwordx4 v[132:135], v92, s[26:27] offset:3584
L_pro2:
    global_load_ushort v255, v254, s[20:21]
    v_mov_b32 v91, 0
    s_mov_b64 s[100:101], s[30:31]
    s_lshr_b32 s46, 131, s3
    s_bitcmp1_b32 s46, 0
    s_cbranch_scc0 L_nopfa
    s_and_b32 s46, s2, 7
    s_mul_i32 s45, s46, 3
    s_min_u32 s46, s46, 4
    s_add_u32 s45, s45, s46
    v_and_b32 v51, 3, v1
    v_add_u32 v51, s45, v51
    v_min_u32 v51, 27, v51
    s_lshr_b32 s44, s2, 3
    s_min_u32 s44, s44, 27
    s_lshl_b32 s44, s44, 4
    s_cmp_eq_u32 s3, 7
    s_cbranch_scc1 L_pfd
    s_cmp_eq_u32 s3, 0
    s_cselect_b64 s[100:101], s[26:27], s[28:29]
    v_lshrrev_b32 v52, 2, v1
    v_add_u32 v52, s44, v52
    v_mul_u32_u24 v52, 3584, v52
    v_lshl_add_u32 v91, v51, 7, v52
    s_branch L_nopfa
L_pfd:
    v_add_u32 v51, s45, v3
    v_min_u32 v51, 27, v51
    v_add_u32 v52, s44, v2
    v_mul_u32_u24 v51, 57344, v51
    v_lshl_add_u32 v91, v52, 7, v51
L_nopfa:

    v_mov_b32 v82, 0x3fb8aa3b
    v_mov_b32 v86, 0x42800000
    s_lshl_b32 s54, s40, 4
    s_mov_b32 s50, 1610637312
    s_cmpk_ge_u32 s2, 224
    s_cbranch_scc1 L_t2
L_t2r:
    s_cmp_eq_u32 s43, 0
    s_cbranch_scc1 L_notf
    s_waitcnt vmcnt(5) lgkmcnt(0)
    s_branch L_ln
L_notf:
    s_cmpk_ge_u32 s2, 224
    s_cbranch_scc1 L_noadr
    s_nop 0
    s_mul_i32 s99, s40, 9920
    s_add_u32 s99, s99, 125824
    v_mul_u32_u24 v51, 1040, v3
    v_lshlrev_b32_e64 v52, 4, v2
    v_add3_u32 v101, v51, v52, m0
    s_lshl_b32 s44, s40, 11
    s_add_u32 s44, s44, 16384
    v_and_b32 v53, 1, v0
    v_mul_u32_u24 v53, 9912, v53
    v_lshl_add_u32 v53, v0, 3, v53
    v_add_u32 v103, 131616, v53
    s_cmp_lt_u32 s3, 4
    s_waitcnt vmcnt(8)

    v_mad_u32_u16 v92, v104, 1, s99 op_sel:[1,0,0,0]
    v_mad_u32_u16 v104, v104, 1, s99 op_sel:[0,0,0,0]
    v_mad_u32_u16 v93, v105, 1, s99 op_sel:[1,0,0,0]
    v_mad_u32_u16 v105, v105, 1, s99 op_sel:[0,0,0,0]
    v_mad_u32_u16 v102, v106, 1, s98 op_sel:[1,0,0,0]
    v_mad_u32_u16 v116, v106, 1, s99 op_sel:[0,0,0,0]
    v_mad_u32_u16 v113, v107, 1, s44 op_sel:[1,0,0,0]
    v_mad_u32_u16 v119, v107, 1, s98 op_sel:[0,0,0,0]
    s_cbranch_scc1 L_madr
    ds_write_b128 v116, v[44:47]
    s_branch L_noadr
L_madr:
    v_lshl_add_u32 v51, v2, 1, v3
    v_lshl_add_u32 v117, v51, 4, s99
    v_lshlrev_b32 v52, 2, v3
    v_sub_u32_e64 v52, v2, v52
    s_add_u32 s44, s99, 60
    v_lshl_add_u32 v118, v52, 2, s44
    s_lshl2_add_u32 s44, s41, s99
    s_nop 0
    s_add_u32 s44, s44, 424
    v_lshl_add_u32 v112, v52, 3, s44
    v_add_u32 v114, 0x400, v116
    v_add_u32 v115, 0x800, v116

    s_mov_b32 s44, 65537
    s_movk_i32 s45, 16256
    v_and_b32 v51, s44, v108
    v_and_b32 v52, s44, v109
    v_mul_u32_u24 v236, s45, v51
    v_mul_u32_u24_e64 v244, s45, v52
    s_mov_b32 s44, 131074
    s_movk_i32 s45, 8128
    v_and_b32 v51, s44, v108
    v_and_b32 v52, s44, v109
    v_mul_u32_u24 v237, s45, v51
    v_mul_u32_u24_e64 v245, s45, v52
    s_mov_b32 s44, 262148
    s_movk_i32 s45, 4064
    v_and_b32 v51, s44, v108
    v_and_b32 v52, s44, v109
    v_mul_u32_u24 v238, s45, v51
    v_mul_u32_u24_e64 v246, s45, v52
    s_mov_b32 s44, 524296
    s_movk_i32 s45, 2032
    v_and_b32 v51, s44, v108
    v_and_b32 v52, s44, v109
    v_mul_u32_u24 v239, s45, v51
    v_mul_u32_u24_e64 v247, s45, v52
    s_mov_b32 s44, 1048592
    s_movk_i32 s45, 1016
    v_and_b32 v51, s44, v108
    v_and_b32 v52, s44, v109
    v_mul_u32_u24 v240, s45, v51
    v_mul_u32_u24_e64 v248, s45, v52
    s_mov_b32 s44, 2097184
    s_movk_i32 s45, 508
    v_and_b32 v51, s44, v108
    v_and_b32 v52, s44, v109
    v_mul_u32_u24 v241, s45, v51
    v_mul_u32_u24_e64 v249, s45, v52
    s_mov_b32 s44, 4194368
    s_movk_i32 s45, 254
    v_and_b32 v51, s44, v108
    v_and_b32 v52, s44, v109
    v_mul_u32_u24 v242, s45, v51
    v_mul_u32_u24_e64 v250, s45, v52
    s_mov_b32 s44, 8388736
    s_movk_i32 s45, 127
    v_and_b32 v51, s44, v108
    v_and_b32 v52, s44, v109
    v_mul_u32_u24 v243, s45, v51
    v_mul_u32_u24 v251, s45, v52
L_noadr:
    s_setprio 0
    s_cmp_lt_u32 s3, 4
    s_cbranch_scc1 L_spa
    s_setprio 1
L_spa:
    s_waitcnt lgkmcnt(0)
    s_lshr_b32 s54, s48, s54
    s_lshl_b32 s54, s54, 16
    v_mul_f32 v83, s54, v82
    v_exp_f32_e64 v83, v83
    s_nop 0
    v_cvt_pk_bf16_f32 v83, 0, v83
    v_mul_f32 v84, -v82, v83
    v_mul_f32_e64 v85, 0.15915494, v83
    s_cmpk_ge_u32 s2, 0
    s_cbranch_scc1 L_w6
    s_waitcnt vmcnt(5)
L_w6:
    s_waitcnt vmcnt(6)
L_ln:
    s_setprio 0
    s_cmp_lt_u32 s3, 4
    s_cbranch_scc1 L_spb
    s_setprio 1
L_spb:
    s_mov_b32 exec_hi, 0x00ffffff
    v_lshlrev_b32 v20, 16, v10
    v_and_b32 v21, s96, v10
    v_readfirstlane_b32 s42, v20
    v_lshlrev_b32 v22, 16, v11
    v_and_b32 v23, s96, v11
    v_lshlrev_b32 v24, 16, v12
    v_and_b32 v25, s96, v12
    v_lshlrev_b32 v26, 16, v13
    v_and_b32_e64 v27, s96, v13
    v_pk_add_f32 v[28:29], v[20:21], s[42:43] op_sel_hi:[1,0] neg_lo:[0,1] neg_hi:[0,1]
    v_pk_add_f32 v[30:31], v[22:23], s[42:43] op_sel_hi:[1,0] neg_lo:[0,1] neg_hi:[0,1]
    v_pk_add_f32 v[32:33], v[24:25], s[42:43] op_sel_hi:[1,0] neg_lo:[0,1] neg_hi:[0,1]
    v_pk_add_f32 v[34:35], v[26:27], s[42:43] op_sel_hi:[1,0] neg_lo:[0,1] neg_hi:[0,1]
    v_pk_mul_f32 v[52:53], v[28:29], v[28:29]
    v_pk_add_f32 v[50:51], v[28:29], v[30:31]
    v_pk_fma_f32 v[52:53], v[30:31], v[30:31], v[52:53]
    v_pk_add_f32 v[50:51], v[50:51], v[32:33]
    v_pk_fma_f32 v[52:53], v[32:33], v[32:33], v[52:53]
    v_pk_add_f32 v[50:51], v[50:51], v[34:35]
    v_pk_fma_f32 v[52:53], v[34:35], v[34:35], v[52:53]
    v_add_f32 v44, v50, v51

    v_dot2c_f32_bf16 v46, v10, v14
    v_dot2c_f32_bf16 v47, s97, v14
    v_dot2c_f32_bf16 v46, v11, v15
    v_dot2c_f32_bf16 v47, s97, v15
    v_dot2c_f32_bf16 v46, v12, v16
    v_dot2c_f32_bf16 v47, s97, v16
    v_dot2c_f32_bf16 v46, v13, v17
    v_dot2c_f32_bf16 v47, s97, v17
    v_add_f32 v45, v52, v53
    ds_write_b128 v18, v[10:13]
    s_mov_b32 exec_hi, -1
    v_permlane32_swap_b32 v44, v45
    v_permlane32_swap_b32 v46, v47
    v_add_f32 v44, v44, v45
    v_add_f32 v46, v46, v47
    s_nop 1
    v_permlane16_swap_b32 v44, v46
    v_add_f32 v44, v44, v46
    s_andn2_b32 s56, s50, s36
    s_nop 0
    v_add_f32_dpp v44, v44, v44 row_ror:8 row_mask:0xf bank_mask:0xf
    s_andn2_b32 s57, s50, s37
    s_nop 0
    v_add_f32_dpp v44, v44, v44 row_ror:4 row_mask:0xf bank_mask:0xf
    s_andn2_b32 s58, s50, s38
    s_andn2_b32 s59, s50, s39
    v_add_f32_dpp v44, v44, v44 row_ror:2 row_mask:0xf bank_mask:0xf
    v_not_b32 v59, s39
    s_nop 0
    v_add_f32_dpp v44, v44, v44 row_ror:1 row_mask:0xf bank_mask:0xf
    v_mul_f32 v45, 0x3b124925, v44
    v_readlane_b32 s47, v44, 16
    v_readlane_b32 s44, v45, 0
    v_readlane_b32 s45, v45, 32
    s_nop 0
    v_mov_b32 v50, s44
    v_fma_f32 v51, -v50, v50, s45
    v_add_f32 v50, s42, v50
    v_max_f32 v51, 0, v51
    v_cvt_pk_bf16_f32 v50, v50, v51
    v_and_b32_e64 v51, s96, v50
    v_add_f32 v51, 0x3727c5ac, v51
    v_cvt_pk_bf16_f32 v51, 0, v51
    v_sqrt_f32 v51, v51
    v_lshlrev_b32 v50, 16, v50
    v_cvt_pk_bf16_f32 v51, 0, v51
    v_rcp_f32 v57, v51
    s_nop 0
    v_mul_f32 v52, 0x1d800000, v57
    v_mul_f32 v58, -v50, v57
    v_mul_f32 v53, -v50, v52

    v_pk_fma_f32 v[20:21], v[20:21], v[52:53], v[52:53] op_sel:[0,0,1] op_sel_hi:[1,0,1]
    v_pk_fma_f32 v[22:23], v[22:23], v[52:53], v[52:53] op_sel:[0,0,1] op_sel_hi:[1,0,1]
    v_pk_fma_f32 v[24:25], v[24:25], v[52:53], v[52:53] op_sel:[0,0,1] op_sel_hi:[1,0,1]
    v_pk_fma_f32 v[26:27], v[26:27], v[52:53], v[52:53] op_sel:[0,0,1] op_sel_hi:[1,0,1]
    v_cvt_pk_bf16_f32 v28, v20, v21
    v_cvt_pk_bf16_f32 v29, v22, v23
    v_cvt_pk_bf16_f32 v30, v24, v25
    v_cvt_pk_bf16_f32 v31, v26, v27
    s_mov_b32 exec_hi, 0x00ffffff
    ds_write_b128 v18, v[28:31] offset:7680
    s_mov_b32 exec_lo, 0
    s_mov_b32 exec_hi, 0x80000000
    v_mul_f32 v56, s47, v57
    v_fmac_f32_e64 v56, v44, v58
    v_cvt_pk_bf16_f32 v56, 0, v56
    v_or_b32_e64 v56, s62, v56
    ds_write_b128 v48, v[56:59]
    s_mov_b64 exec, -1

    s_cmpk_ge_u32 s2, 224
    s_cbranch_scc1 L_pubf0
    s_setprio 1
    s_waitcnt lgkmcnt(0)
    s_barrier
    s_cmp_eq_u32 s3, 7
    s_cbranch_scc1 L_candc
    ds_read_b64_tr_b16 v[20:21], v19 offset:7680
    ds_read_b64_tr_b16 v[22:23], v19 offset:11520
    s_branch L_rdc
L_candc:
    s_nop 0
    v_and_b32 v50, 0x70, v4
    v_add_u32 v50, 125696, v50
    ds_read_b128 v[56:59], v50
    s_lshl_b32 s44, s6, 4
    s_add_u32 s44, s44, 8192
    v_mov_b32 v55, s44
L_rdc:

    s_cmp_eq_u32 s3, 7
    s_waitcnt lgkmcnt(0)
    s_cbranch_scc1 L_cand2c
    v_or_b32 v20, s56, v20
    v_or_b32 v21, s57, v21
    v_or_b32 v22, s58, v22
    v_or_b32_e64 v23, s59, v23
    global_store_dwordx4 v49, v[20:23], s[60:61] sc1
    s_branch L_pubc
L_cand2c:
    v_max_f32_dpp v50, v56, v56 row_ror:4 row_mask:0xf bank_mask:0xf
    s_nop 1
    v_max_f32_dpp v50, v50, v50 row_ror:2 row_mask:0xf bank_mask:0xf
    s_nop 1
    v_max_f32_dpp v50, v50, v50 row_ror:1 row_mask:0xf bank_mask:0xf
    v_cmp_eq_u32 vcc, v50, v56
    s_and_b32 exec_lo, vcc_lo, 0xff
    s_mov_b32 exec_hi, 0
    global_store_dwordx4 v55, v[56:59], s[34:35] offset:-4096 sc1

    s_mov_b64 exec, -1
L_pubc:

    s_waitcnt vmcnt(2)
    s_lshr_b32 s44, 3, s3
    s_bitcmp1_b32 s44, 0
    s_cbranch_scc0 L_pfp
    global_load_dword v9, v91, s[100:101]
    v_mov_b32 v91, 0
L_pfp:
    v_mul_f32 v40, v82, v40
    v_max_f32 v54, abs(v42), abs(v43)
    v_exp_f32 v40, v40
    s_nop 0
    v_max_f32_dpp v54, v54, v54 row_ror:8 row_mask:0xf bank_mask:0xf
    v_cvt_pk_bf16_f32 v40, 0, v40
    v_pk_mul_f32 v[40:41], v[40:41], v[84:85]
    v_max_f32_dpp v54, v54, v54 row_ror:4 row_mask:0xf bank_mask:0xf
    v_pk_mul_f32 v[80:81], v[40:41], v[86:87] op_sel_hi:[1,0]
    v_fract_f32_e64 v41, v41
    v_max_f32_dpp v54, v54, v54 row_ror:2 row_mask:0xf bank_mask:0xf
    v_fract_f32 v81, v81
    v_exp_f32 v40, v40
    v_max_f32_dpp v54, v54, v54 row_ror:1 row_mask:0xf bank_mask:0xf
    v_cos_f32 v60, v41
    v_sin_f32 v61, v41
    v_max_f32_dpp v54, v54, v54 row_bcast:15 row_mask:0xa bank_mask:0xf
    v_exp_f32 v80, v80
    v_cos_f32 v72, v81
    v_max_f32_dpp v54, v54, v54 row_bcast:31 row_mask:0xc bank_mask:0xf
    v_sin_f32_e64 v73, v81
    v_readlane_b32 s54, v54, 63
    v_pk_mul_f32 v[60:61], v[60:61], v[40:41] op_sel_hi:[1,0]
    v_pk_mul_f32 v[72:73], v[72:73], v[80:81] op_sel_hi:[1,0]
    s_lshr_b32 s54, s54, 23
    s_max_u32 s54, s54, 14
    s_sub_u32 s52, 267, s54
    s_lshl_b32 s52, s52, 23
    s_nop 0
    v_pk_mul_f32 v[62:63], v[60:61], v[60:61] op_sel:[0,0] op_sel_hi:[0,1]
    v_pk_mul_f32 v[74:75], v[72:73], v[72:73] op_sel:[0,0] op_sel_hi:[0,1]
    v_pk_fma_f32 v[62:63], v[60:61], v[60:61], v[62:63] op_sel:[1,1,0] op_sel_hi:[1,0,1] neg_lo:[0,1,0]
    v_pk_fma_f32 v[74:75], v[72:73], v[72:73], v[74:75] op_sel:[1,1,0] op_sel_hi:[1,0,1] neg_lo:[0,1,0]
    v_cvt_pk_f16_f32 v173, v60, -v61
    v_cvt_pk_f16_f32 v149, v72, v73
    v_pk_mul_f32 v[64:65], v[62:63], v[62:63] op_sel:[0,0] op_sel_hi:[0,1]
    v_pk_mul_f32 v[76:77], v[74:75], v[74:75] op_sel:[0,0] op_sel_hi:[0,1]
    v_pk_fma_f32 v[64:65], v[62:63], v[62:63], v[64:65] op_sel:[1,1,0] op_sel_hi:[1,0,1] neg_lo:[0,1,0]
    v_pk_fma_f32 v[76:77], v[74:75], v[74:75], v[76:77] op_sel:[1,1,0] op_sel_hi:[1,0,1] neg_lo:[0,1,0]
    v_cvt_pk_f16_f32 v174, v62, -v63
    v_cvt_pk_f16_f32 v157, v74, v75
    v_pk_mul_f32 v[66:67], v[64:65], v[64:65] op_sel:[0,0] op_sel_hi:[0,1]
    ds_write_addtid_b32 v149 offset:30160
    v_pk_fma_f32 v[66:67], v[64:65], v[64:65], v[66:67] op_sel:[1,1,0] op_sel_hi:[1,0,1] neg_lo:[0,1,0]
    v_pk_mul_f32 v[78:79], v[76:77], v[76:77] op_sel:[0,0] op_sel_hi:[0,1]
    v_cvt_pk_f16_f32 v175, v64, -v65
    v_pk_fma_f32 v[78:79], v[76:77], v[76:77], v[78:79] op_sel:[1,1,0] op_sel_hi:[1,0,1] neg_lo:[0,1,0]
    v_pk_mul_f32 v[68:69], v[66:67], v[66:67] op_sel:[0,0] op_sel_hi:[0,1]
    v_cvt_pk_f16_f32 v176, v76, -v77
    v_pk_fma_f32 v[68:69], v[66:67], v[66:67], v[68:69] op_sel:[1,1,0] op_sel_hi:[1,0,1] neg_lo:[0,1,0]
    ds_write_addtid_b32 v157 offset:38480
    v_cvt_pk_f16_f32 v142, v66, v67
    v_pk_mul_f32 v[80:81], v[78:79], v[78:79] op_sel:[0,0] op_sel_hi:[0,1]
    v_pk_mul_f32 v[70:71], v[68:69], v[68:69] op_sel:[0,0] op_sel_hi:[0,1]
    v_pk_fma_f32 v[80:81], v[78:79], v[78:79], v[80:81] op_sel:[1,1,0] op_sel_hi:[1,0,1] neg_lo:[0,1,0]
    v_pk_fma_f32 v[70:71], v[68:69], v[68:69], v[70:71] op_sel:[1,1,0] op_sel_hi:[1,0,1] neg_lo:[0,1,0]
    v_cvt_pk_f16_f32 v177, v78, -v79
    v_cvt_pk_f16_f32 v143, v68, v69
    v_pk_mul_f32 v[42:43], v[42:43], s[52:53] op_sel_hi:[1,0]
    ds_write_addtid_b32 v142 offset:22880
    v_cvt_pk_f16_f32 v178, v80, -v81
    v_cvt_pk_f16_f32 v145, v70, v71
    v_cvt_pk_f16_f32 v120, v42, -v43
    ds_write_addtid_b32 v143 offset:23920
    s_sub_u32 s54, s54, 12
    ds_write_addtid_b32 v145 offset:26000
    ds_write_addtid_b32 v120 offset:0
    s_lshl_b32 s54, s54, 23
    v_mul_f32 v88, s54, v83
    s_setprio 0
    v_pk_mul_f16 v121, v120, v173 op_sel:[0,0] op_sel_hi:[0,1]
    v_pk_mul_f16 v144, v142, v143 op_sel:[0,0] op_sel_hi:[0,1]
    v_pk_fma_f16 v121, v120, v173, v121 op_sel:[1,1,0] op_sel_hi:[1,0,1] neg_lo:[0,1,0]
    v_pk_fma_f16 v144, v142, v143, v144 op_sel:[1,1,0] op_sel_hi:[1,0,1] neg_lo:[0,1,0]
    ds_write_addtid_b32 v121 offset:1040
    ds_write_addtid_b32 v144 offset:24960
    v_pk_mul_f16 v122, v120, v174 op_sel:[0,0] op_sel_hi:[0,1]
    v_pk_mul_f16 v146, v142, v145 op_sel:[0,0] op_sel_hi:[0,1]
    v_pk_fma_f16 v122, v120, v174, v122 op_sel:[1,1,0] op_sel_hi:[1,0,1] neg_lo:[0,1,0]
    v_pk_fma_f16 v146, v142, v145, v146 op_sel:[1,1,0] op_sel_hi:[1,0,1] neg_lo:[0,1,0]
    ds_write_addtid_b32 v122 offset:2080
    ds_write_addtid_b32 v146 offset:27040
    v_pk_mul_f16 v124, v120, v175 op_sel:[0,0] op_sel_hi:[0,1]
    v_pk_mul_f16 v147, v143, v145 op_sel:[0,0] op_sel_hi:[0,1]
    v_pk_fma_f16 v124, v120, v175, v124 op_sel:[1,1,0] op_sel_hi:[1,0,1] neg_lo:[0,1,0]
    v_pk_fma_f16 v147, v143, v145, v147 op_sel:[1,1,0] op_sel_hi:[1,0,1] neg_lo:[0,1,0]
    ds_write_addtid_b32 v124 offset:4160
    ds_write_addtid_b32 v147 offset:28080
    v_pk_mul_f16 v128, v120, v176 op_sel:[0,0] op_sel_hi:[0,1]
    v_pk_mul_f16 v148, v144, v145 op_sel:[0,0] op_sel_hi:[0,1]
    v_pk_fma_f16 v128, v120, v176, v128 op_sel:[1,1,0] op_sel_hi:[1,0,1] neg_lo:[0,1,0]
    v_pk_fma_f16 v148, v144, v145, v148 op_sel:[1,1,0] op_sel_hi:[1,0,1] neg_lo:[0,1,0]
    ds_write_addtid_b32 v128 offset:8320
    ds_write_addtid_b32 v148 offset:29120
    v_pk_mul_f16 v123, v121, v174 op_sel:[0,0] op_sel_hi:[0,1]
    v_pk_mul_f16 v150, v142, v149 op_sel:[0,0] op_sel_hi:[0,1]
    v_pk_fma_f16 v123, v121, v174, v123 op_sel:[1,1,0] op_sel_hi:[1,0,1] neg_lo:[0,1,0]
    v_pk_fma_f16 v150, v142, v149, v150 op_sel:[1,1,0] op_sel_hi:[1,0,1] neg_lo:[0,1,0]
    ds_write_addtid_b32 v123 offset:3120
    ds_write_addtid_b32 v150 offset:31200
    v_pk_mul_f16 v132, v120, v177 op_sel:[0,0] op_sel_hi:[0,1]
    v_pk_mul_f16 v151, v143, v149 op_sel:[0,0] op_sel_hi:[0,1]
    v_pk_fma_f16 v132, v120, v177, v132 op_sel:[1,1,0] op_sel_hi:[1,0,1] neg_lo:[0,1,0]
    v_pk_fma_f16 v151, v143, v149, v151 op_sel:[1,1,0] op_sel_hi:[1,0,1] neg_lo:[0,1,0]
    ds_write_addtid_b32 v132 offset:12480
    ds_write_addtid_b32 v151 offset:32240
    v_pk_mul_f16 v125, v121, v175 op_sel:[0,0] op_sel_hi:[0,1]
    v_pk_mul_f16 v152, v144, v149 op_sel:[0,0] op_sel_hi:[0,1]
    v_pk_fma_f16 v125, v121, v175, v125 op_sel:[1,1,0] op_sel_hi:[1,0,1] neg_lo:[0,1,0]
    v_pk_fma_f16 v152, v144, v149, v152 op_sel:[1,1,0] op_sel_hi:[1,0,1] neg_lo:[0,1,0]
    ds_write_addtid_b32 v125 offset:5200
    ds_write_addtid_b32 v152 offset:33280
    v_pk_mul_f16 v126, v122, v175 op_sel:[0,0] op_sel_hi:[0,1]
    v_pk_mul_f16 v153, v145, v149 op_sel:[0,0] op_sel_hi:[0,1]
    v_pk_fma_f16 v126, v122, v175, v126 op_sel:[1,1,0] op_sel_hi:[1,0,1] neg_lo:[0,1,0]
    v_pk_fma_f16 v153, v145, v149, v153 op_sel:[1,1,0] op_sel_hi:[1,0,1] neg_lo:[0,1,0]
    ds_write_addtid_b32 v126 offset:6240
    ds_write_addtid_b32 v153 offset:34320
    v_pk_mul_f16 v127, v123, v175 op_sel:[0,0] op_sel_hi:[0,1]
    v_pk_mul_f16 v154, v146, v149 op_sel:[0,0] op_sel_hi:[0,1]
    v_pk_fma_f16 v127, v123, v175, v127 op_sel:[1,1,0] op_sel_hi:[1,0,1] neg_lo:[0,1,0]
    v_pk_fma_f16 v154, v146, v149, v154 op_sel:[1,1,0] op_sel_hi:[1,0,1] neg_lo:[0,1,0]
    ds_write_addtid_b32 v127 offset:7280
    ds_write_addtid_b32 v154 offset:35360
    v_pk_mul_f16 v129, v122, v176 op_sel:[0,0] op_sel_hi:[0,1]
    v_pk_mul_f16 v155, v147, v149 op_sel:[0,0] op_sel_hi:[0,1]
    v_pk_fma_f16 v129, v122, v176, v129 op_sel:[1,1,0] op_sel_hi:[1,0,1] neg_lo:[0,1,0]
    v_pk_fma_f16 v155, v147, v149, v155 op_sel:[1,1,0] op_sel_hi:[1,0,1] neg_lo:[0,1,0]
    ds_write_addtid_b32 v129 offset:9360
    ds_write_addtid_b32 v155 offset:36400
    v_pk_mul_f16 v130, v124, v176 op_sel:[0,0] op_sel_hi:[0,1]
    v_pk_mul_f16 v156, v148, v149 op_sel:[0,0] op_sel_hi:[0,1]
    v_pk_fma_f16 v130, v124, v176, v130 op_sel:[1,1,0] op_sel_hi:[1,0,1] neg_lo:[0,1,0]
    v_pk_fma_f16 v156, v148, v149, v156 op_sel:[1,1,0] op_sel_hi:[1,0,1] neg_lo:[0,1,0]
    ds_write_addtid_b32 v130 offset:10400
    ds_write_addtid_b32 v156 offset:37440
    v_pk_mul_f16 v131, v126, v176 op_sel:[0,0] op_sel_hi:[0,1]
    v_pk_mul_f16 v158, v142, v157 op_sel:[0,0] op_sel_hi:[0,1]
    v_pk_fma_f16 v131, v126, v176, v131 op_sel:[1,1,0] op_sel_hi:[1,0,1] neg_lo:[0,1,0]
    v_pk_fma_f16 v158, v142, v157, v158 op_sel:[1,1,0] op_sel_hi:[1,0,1] neg_lo:[0,1,0]
    ds_write_addtid_b32 v131 offset:11440
    ds_write_addtid_b32 v158 offset:39520
    v_pk_mul_f16 v133, v124, v177 op_sel:[0,0] op_sel_hi:[0,1]
    v_pk_mul_f16 v159, v143, v157 op_sel:[0,0] op_sel_hi:[0,1]
    v_pk_fma_f16 v133, v124, v177, v133 op_sel:[1,1,0] op_sel_hi:[1,0,1] neg_lo:[0,1,0]
    v_pk_fma_f16 v159, v143, v157, v159 op_sel:[1,1,0] op_sel_hi:[1,0,1] neg_lo:[0,1,0]
    ds_write_addtid_b32 v133 offset:13520
    ds_write_addtid_b32 v159 offset:40560
    v_pk_mul_f16 v134, v128, v177 op_sel:[0,0] op_sel_hi:[0,1]
    v_pk_mul_f16 v160, v144, v157 op_sel:[0,0] op_sel_hi:[0,1]
    v_pk_fma_f16 v134, v128, v177, v134 op_sel:[1,1,0] op_sel_hi:[1,0,1] neg_lo:[0,1,0]
    v_pk_fma_f16 v160, v144, v157, v160 op_sel:[1,1,0] op_sel_hi:[1,0,1] neg_lo:[0,1,0]
    ds_write_addtid_b32 v134 offset:14560
    ds_write_addtid_b32 v160 offset:41600
    v_pk_mul_f16 v135, v130, v177 op_sel:[0,0] op_sel_hi:[0,1]
    v_pk_mul_f16 v161, v145, v157 op_sel:[0,0] op_sel_hi:[0,1]
    v_pk_fma_f16 v135, v130, v177, v135 op_sel:[1,1,0] op_sel_hi:[1,0,1] neg_lo:[0,1,0]
    v_pk_fma_f16 v161, v145, v157, v161 op_sel:[1,1,0] op_sel_hi:[1,0,1] neg_lo:[0,1,0]
    ds_write_addtid_b32 v135 offset:15600
    ds_write_addtid_b32 v161 offset:42640
    v_pk_mul_f16 v136, v120, v178 op_sel:[0,0] op_sel_hi:[0,1]
    v_pk_mul_f16 v162, v146, v157 op_sel:[0,0] op_sel_hi:[0,1]
    v_pk_fma_f16 v136, v120, v178, v136 op_sel:[1,1,0] op_sel_hi:[1,0,1] neg_lo:[0,1,0]
    v_pk_fma_f16 v162, v146, v157, v162 op_sel:[1,1,0] op_sel_hi:[1,0,1] neg_lo:[0,1,0]
    ds_write_addtid_b32 v136 offset:16640
    ds_write_addtid_b32 v162 offset:43680
    v_pk_mul_f16 v137, v128, v178 op_sel:[0,0] op_sel_hi:[0,1]
    v_pk_mul_f16 v163, v147, v157 op_sel:[0,0] op_sel_hi:[0,1]
    v_pk_fma_f16 v137, v128, v178, v137 op_sel:[1,1,0] op_sel_hi:[1,0,1] neg_lo:[0,1,0]
    v_pk_fma_f16 v163, v147, v157, v163 op_sel:[1,1,0] op_sel_hi:[1,0,1] neg_lo:[0,1,0]
    ds_write_addtid_b32 v137 offset:17680
    ds_write_addtid_b32 v163 offset:44720
    v_pk_mul_f16 v138, v132, v178 op_sel:[0,0] op_sel_hi:[0,1]
    v_pk_mul_f16 v164, v148, v157 op_sel:[0,0] op_sel_hi:[0,1]
    v_pk_fma_f16 v138, v132, v178, v138 op_sel:[1,1,0] op_sel_hi:[1,0,1] neg_lo:[0,1,0]
    v_pk_fma_f16 v164, v148, v157, v164 op_sel:[1,1,0] op_sel_hi:[1,0,1] neg_lo:[0,1,0]
    ds_write_addtid_b32 v138 offset:18720
    ds_write_addtid_b32 v164 offset:45760
    v_pk_mul_f16 v139, v134, v178 op_sel:[0,0] op_sel_hi:[0,1]
    v_pk_mul_f16 v165, v149, v157 op_sel:[0,0] op_sel_hi:[0,1]
    v_pk_fma_f16 v139, v134, v178, v139 op_sel:[1,1,0] op_sel_hi:[1,0,1] neg_lo:[0,1,0]
    v_pk_fma_f16 v165, v149, v157, v165 op_sel:[1,1,0] op_sel_hi:[1,0,1] neg_lo:[0,1,0]
    ds_write_addtid_b32 v139 offset:19760
    ds_write_addtid_b32 v165 offset:46800
    v_pk_mul_f16 v140, v136, v178 op_sel:[0,0] op_sel_hi:[0,1]
    v_pk_mul_f16 v166, v150, v157 op_sel:[0,0] op_sel_hi:[0,1]
    v_pk_fma_f16 v140, v136, v178, v140 op_sel:[1,1,0] op_sel_hi:[1,0,1] neg_lo:[0,1,0]
    v_pk_fma_f16 v166, v150, v157, v166 op_sel:[1,1,0] op_sel_hi:[1,0,1] neg_lo:[0,1,0]
    ds_write_addtid_b32 v140 offset:20800
    ds_write_addtid_b32 v166 offset:47840
    v_pk_mul_f16 v170, v154, v157 op_sel:[0,0] op_sel_hi:[0,1]
    v_pk_mul_f16 v167, v151, v157 op_sel:[0,0] op_sel_hi:[0,1]
    v_pk_fma_f16 v170, v154, v157, v170 op_sel:[1,1,0] op_sel_hi:[1,0,1] neg_lo:[0,1,0]
    v_pk_fma_f16 v167, v151, v157, v167 op_sel:[1,1,0] op_sel_hi:[1,0,1] neg_lo:[0,1,0]
    ds_write_addtid_b32 v170 offset:52000
    ds_write_addtid_b32 v167 offset:48880
    v_pk_mul_f16 v171, v155, v157 op_sel:[0,0] op_sel_hi:[0,1]
    v_pk_mul_f16 v168, v152, v157 op_sel:[0,0] op_sel_hi:[0,1]
    v_pk_fma_f16 v171, v155, v157, v171 op_sel:[1,1,0] op_sel_hi:[1,0,1] neg_lo:[0,1,0]
    v_pk_fma_f16 v168, v152, v157, v168 op_sel:[1,1,0] op_sel_hi:[1,0,1] neg_lo:[0,1,0]
    ds_write_addtid_b32 v171 offset:53040
    ds_write_addtid_b32 v168 offset:49920
    v_pk_mul_f16 v172, v156, v157 op_sel:[0,0] op_sel_hi:[0,1]
    v_pk_mul_f16 v169, v153, v157 op_sel:[0,0] op_sel_hi:[0,1]
    v_pk_fma_f16 v172, v156, v157, v172 op_sel:[1,1,0] op_sel_hi:[1,0,1] neg_lo:[0,1,0]
    v_pk_fma_f16 v169, v153, v157, v169 op_sel:[1,1,0] op_sel_hi:[1,0,1] neg_lo:[0,1,0]
    ds_write_addtid_b32 v172 offset:54080
    ds_write_addtid_b32 v169 offset:50960
    global_load_dwordx4 v[72:75], v90, s[60:61] sc1
    ds_read_b128 v[120:123], v100 offset:0
    ds_read_b128 v[124:127], v100 offset:21840
    ds_read_b128 v[128:131], v100 offset:32
    ds_read_b128 v[132:135], v100 offset:21872
    ds_read_b128 v[136:139], v100 offset:64
    ds_read_b128 v[140:143], v100 offset:21904
    ds_read_b128 v[144:147], v100 offset:96
    ds_read_b128 v[148:151], v100 offset:21936
    s_sub_u32 s52, 570434048, s56
    s_sub_u32 s53, 570434048, s57
    s_sub_u32 s54, 570434048, s58
    s_sub_u32 s55, 570434048, s59
    s_waitcnt lgkmcnt(6)
    v_mfma_f32_32x32x16_f16 v[20:35], v[120:123], v[124:127], 0
    ds_read_b128 v[152:155], v100 offset:128
    ds_read_b128 v[156:159], v100 offset:21968
    s_waitcnt lgkmcnt(6)
    v_mfma_f32_32x32x16_f16 v[20:35], v[128:131], v[132:135], v[20:35]
    ds_read_b128 v[160:163], v100 offset:160
    ds_read_b128 v[164:167], v100 offset:22000
    s_waitcnt lgkmcnt(6)
    v_mfma_f32_32x32x16_f16 v[20:35], v[136:139], v[140:143], v[20:35]
    ds_read_b128 v[168:171], v100 offset:192
    ds_read_b128 v[172:175], v100 offset:22032
    s_waitcnt lgkmcnt(6)
    v_mfma_f32_32x32x16_f16 v[20:35], v[144:147], v[148:151], v[20:35]
    ds_read_b128 v[176:179], v100 offset:224
    ds_read_b128 v[180:183], v100 offset:22064
    s_waitcnt lgkmcnt(6)
    v_mfma_f32_32x32x16_f16 v[20:35], v[152:155], v[156:159], v[20:35]
    s_waitcnt lgkmcnt(4)
    v_mfma_f32_32x32x16_f16 v[20:35], v[160:163], v[164:167], v[20:35]
    s_waitcnt lgkmcnt(2)
    v_mfma_f32_32x32x16_f16 v[20:35], v[168:171], v[172:175], v[20:35]
    s_waitcnt lgkmcnt(0)
    v_mfma_f32_32x32x16_f16 v[20:35], v[176:179], v[180:183], v[20:35]
    s_nop 11
    s_nop 0
    v_pk_mul_f32 v[20:21], v[20:21], v[88:89] op_sel_hi:[1,0]
    v_pk_mul_f32 v[22:23], v[22:23], v[88:89] op_sel_hi:[1,0]
    ds_write_b128 v101, v[20:23] offset:0
    v_pk_mul_f32 v[24:25], v[24:25], v[88:89] op_sel_hi:[1,0]
    v_pk_mul_f32 v[26:27], v[26:27], v[88:89] op_sel_hi:[1,0]
    ds_write_b128 v101, v[24:27] offset:4160
    v_pk_mul_f32 v[28:29], v[28:29], v[88:89] op_sel_hi:[1,0]
    v_pk_mul_f32 v[30:31], v[30:31], v[88:89] op_sel_hi:[1,0]
    ds_write_b128 v101, v[28:31] offset:8320
    s_cmp_lt_u32 s3, 4
    s_cbranch_scc1 L_t1
L_t1r:
    s_waitcnt lgkmcnt(0)
    s_barrier
    ds_read_b128 v[20:23], v102 offset:0
    ds_read_b128 v[24:27], v102 offset:256
    ds_read_b128 v[28:31], v102 offset:512
    ds_read_b128 v[32:35], v102 offset:768
    s_waitcnt vmcnt(0)
    v_xor_b32 v40, s56, v72
    v_bitop3_b32 v40, v40, v73, s57 bitop3:0xf6
    v_bitop3_b32 v40, v40, v74, s58 bitop3:0xf6
    v_bitop3_b32 v40, v40, v75, s59 bitop3:0xf6
    v_and_b32 v40, 1610637312, v40
    v_cmp_ne_u32 vcc, 0, v40

    v_add_u32 v72, s52, v72
    v_add_u32 v73, s53, v73
    v_add_u32 v74, s54, v74
    v_add_u32_e64 v75, s55, v75
    ds_write_b128 v103, v[72:75]
    s_cmp_lt_u32 s3, 4
    s_waitcnt lgkmcnt(1)
    v_pk_add_f32 v[20:21], v[20:21], v[24:25]
    v_pk_add_f32 v[22:23], v[22:23], v[26:27]
    v_pk_add_f32 v[28:29], v[28:29], v[32:33]
    v_pk_add_f32 v[30:31], v[30:31], v[34:35]
    v_pk_add_f32 v[20:21], v[20:21], v[28:29]
    v_pk_add_f32 v[22:23], v[22:23], v[30:31]
    v_cvt_pk_bf16_f32 v50, v20, v21
    v_cvt_pk_bf16_f32 v51, v22, v23

    s_cbranch_scc1 L_rgen
    s_nop 0
    v_perm_b32 v52, v51, v50, v108
    v_perm_b32 v53, v51, v50, v109
    ds_write_b32 v104, v52
    ds_write_b16 v105, v52
    v_alignbit_b32 v54, v53, v52, 16
    ds_write_b32 v92, v53
    ds_write_b16_d16_hi v93, v53
    ds_write_b32 v105, v54 offset:2
    s_branch L_rdone
L_rgen:
    s_nop 0
    ds_write_b16 v104, v50
    ds_write_b16_d16_hi v92, v50
    ds_write_b16 v105, v51
    ds_write_b16_d16_hi v93, v51
L_rdone:

    s_cbranch_vccz L_poll1_done
    s_mov_b32 s50, 0
L_poll1:
    s_mov_b64 exec, vcc
    s_waitcnt lgkmcnt(0)
    global_load_dwordx4 v[72:75], v90, s[60:61] sc1
    s_add_u32 s50, s50, 1

    s_waitcnt vmcnt(0)
    v_xor_b32_e64 v40, s56, v72
    v_bitop3_b32 v40, v40, v73, s57 bitop3:0xf6
    v_bitop3_b32 v40, v40, v74, s58 bitop3:0xf6
    v_bitop3_b32 v40, v40, v75, s59 bitop3:0xf6
    v_and_b32 v40, 1610637312, v40
    v_cmp_ne_u32 vcc, 0, v40

    v_add_u32 v72, s52, v72
    v_add_u32 v73, s53, v73
    v_add_u32 v74, s54, v74
    v_add_u32_e64 v75, s55, v75
    ds_write_b128 v103, v[72:75]
    s_cmp_ge_u32 s50, 200000
    s_cbranch_scc1 L_poll1_out
    s_cbranch_vccnz L_poll1
L_poll1_out:
    s_mov_b64 exec, -1
L_poll1_done:

    s_setprio 0
    s_cmp_lt_u32 s3, 4
    s_cbranch_scc1 L_m
    s_waitcnt lgkmcnt(0)
    s_barrier
    s_branch L_helper
L_m:
    s_bitcmp1_b32 s3, 0
    s_cbranch_scc1 L_ty1

    s_nop 0
    s_waitcnt lgkmcnt(0)
    s_barrier
    ds_read2_b32 v[120:121], v115 offset0:0 offset1:1
    ds_read2_b32 v[122:123], v115 offset0:2 offset1:3
    ds_read_b128 v[124:127], v117 offset:5760
    ds_read_b128 v[128:131], v117 offset:6272
    ds_read2_b32 v[132:133], v114 offset0:128 offset1:129
    ds_read2_b32 v[134:135], v114 offset0:130 offset1:131
    ds_read_b128 v[136:139], v117 offset:5744
    ds_read_b128 v[140:143], v117 offset:6784
    ds_read2_b32 v[144:145], v114 offset0:0 offset1:1
    ds_read2_b32 v[146:147], v114 offset0:2 offset1:3
    s_waitcnt lgkmcnt(7)
    v_mfma_f32_16x16x32_bf16 v[20:23], v[120:123], v[124:127], 0
    ds_read_b128 v[148:151], v117 offset:7296
    s_waitcnt lgkmcnt(7)
    v_mfma_f32_16x16x32_bf16 v[24:27], v[120:123], v[128:131], 0
    ds_read_b128 v[152:155], v117 offset:6256
    s_waitcnt lgkmcnt(6)
    v_mfma_f32_16x16x32_bf16 v[24:27], v[132:135], v[124:127], v[24:27]
    ds_read_b128 v[156:159], v117 offset:7808
    s_waitcnt lgkmcnt(6)
    v_mfma_f32_16x16x32_bf16 v[52:55], v[136:139], v[244:247], 0
    ds_read2_b32 v[160:161], v116 offset0:0 offset1:1
    s_waitcnt lgkmcnt(6)
    v_mfma_f32_16x16x32_bf16 v[28:31], v[120:123], v[140:143], 0
    ds_read2_b32 v[162:163], v116 offset0:2 offset1:3
    v_mfma_f32_16x16x32_bf16 v[56:59], v[136:139], v[248:251], 0
    ds_read_b128 v[168:171], v117 offset:8320
    v_mfma_f32_16x16x32_bf16 v[28:31], v[132:135], v[128:131], v[28:31]
    ds_read_b64 v[172:173], v117 offset:6760
    s_waitcnt lgkmcnt(7)
    v_mfma_f32_16x16x32_bf16 v[28:31], v[144:147], v[124:127], v[28:31]
    ds_read_b64 v[174:175], v117 offset:6768
    s_waitcnt lgkmcnt(7)
    v_mfma_f32_16x16x32_bf16 v[32:35], v[120:123], v[148:151], 0
    ds_read_b128 v[176:179], v117 offset:8832
    v_mfma_f32_16x16x32_bf16 v[32:35], v[132:135], v[140:143], v[32:35]
    ds_read2_b32 v[180:181], v112 offset0:6 offset1:4
    v_cvt_pk_bf16_f32 v164, v52, v56
    v_mfma_f32_16x16x32_bf16 v[32:35], v[144:147], v[128:131], v[32:35]
    ds_read2_b32 v[182:183], v112 offset0:2 offset1:0
    s_waitcnt lgkmcnt(8)
    v_mfma_f32_16x16x32_bf16 v[84:87], v[152:155], v[244:247], 0
    ds_read2_b32 v[184:185], v112 offset0:38 offset1:36
    v_cvt_pk_bf16_f32 v165, v53, v57
    v_mfma_f32_16x16x32_bf16 v[36:39], v[120:123], v[156:159], 0
    ds_read2_b32 v[186:187], v112 offset0:34 offset1:32
    v_cvt_pk_bf16_f32 v166, v54, v58
    v_mfma_f32_16x16x32_bf16 v[88:91], v[152:155], v[248:251], 0
    ds_read2_b32 v[192:193], v112 offset0:70 offset1:68
    v_cvt_pk_bf16_f32 v167, v55, v59
    v_mfma_f32_16x16x32_bf16 v[36:39], v[132:135], v[148:151], v[36:39]
    ds_read2_b32 v[194:195], v112 offset0:66 offset1:64
    v_mfma_f32_16x16x32_bf16 v[36:39], v[144:147], v[140:143], v[36:39]
    ds_read_b128 v[196:199], v117 offset:6768
    s_waitcnt lgkmcnt(10)
    v_mfma_f32_16x16x32_bf16 v[36:39], v[160:163], v[124:127], v[36:39]
    ds_read_b128 v[200:203], v117 offset:9344
    v_mfma_f32_16x16x32_bf16 v[40:43], v[120:123], v[168:171], 0
    ds_read_b128 v[204:207], v117 offset:7280
    v_cvt_pk_bf16_f32 v188, v84, v88
    v_mfma_f32_16x16x32_bf16 v[40:43], v[132:135], v[156:159], v[40:43]
    ds_read2_b32 v[208:209], v114 offset0:224 offset1:225
    s_waitcnt lgkmcnt(11)
    v_mfma_f32_16x16x32_bf16 v[52:55], v[172:175], v[236:239], 0
    ds_read2_b32 v[210:211], v114 offset0:226 offset1:227
    v_cvt_pk_bf16_f32 v189, v85, v89
    v_mfma_f32_16x16x32_bf16 v[40:43], v[144:147], v[148:151], v[40:43]
    v_cvt_pk_bf16_f32 v190, v86, v90
    v_cvt_pk_bf16_f32 v191, v87, v91
    v_mfma_f32_16x16x32_bf16 v[56:59], v[172:175], v[240:243], 0
    v_mfma_f32_16x16x32_bf16 v[40:43], v[160:163], v[128:131], v[40:43]
    ds_read_b128 v[216:219], v117 offset:5632
    s_waitcnt lgkmcnt(12)
    v_mfma_f32_16x16x32_bf16 v[44:47], v[120:123], v[176:179], 0
    v_mfma_f32_16x16x32_bf16 v[44:47], v[132:135], v[168:171], v[44:47]
    v_mfma_f32_16x16x32_bf16 v[44:47], v[144:147], v[156:159], v[44:47]
    ds_read_b128 v[220:223], v117 offset:6144
    s_waitcnt lgkmcnt(9)
    v_mfma_f32_16x16x32_bf16 v[28:31], v[164:167], v[180:183], v[28:31]
    ds_read2_b32 v[224:225], v114 offset0:96 offset1:97
    v_cvt_pk_bf16_f32 v212, v52, v56
    v_mfma_f32_16x16x32_bf16 v[32:35], v[164:167], v[184:187], v[32:35]
    ds_read2_b32 v[226:227], v114 offset0:98 offset1:99
    s_waitcnt lgkmcnt(8)
    v_mfma_f32_16x16x32_bf16 v[36:39], v[164:167], v[192:195], v[36:39]
    ds_read_b128 v[228:231], v117 offset:6656
    v_cvt_pk_bf16_f32 v213, v53, v57
    v_mfma_f32_16x16x32_bf16 v[84:87], v[196:199], v[244:247], 0
    ds_read_b128 v[232:235], v117 offset:7792
    v_cvt_pk_bf16_f32 v214, v54, v58
    v_mfma_f32_16x16x32_bf16 v[44:47], v[160:163], v[140:143], v[44:47]
    ds_read_b128 v[60:63], v117 offset:7168
    v_cvt_pk_bf16_f32 v215, v55, v59
    v_mfma_f32_16x16x32_bf16 v[88:91], v[196:199], v[248:251], 0
    ds_read_b128 v[68:71], v117 offset:7680
    s_waitcnt lgkmcnt(11)
    v_mfma_f32_16x16x32_bf16 v[48:51], v[120:123], v[200:203], 0
    ds_read_b128 v[72:75], v117 offset:8192
    v_mfma_f32_16x16x32_bf16 v[48:51], v[132:135], v[176:179], v[48:51]
    v_mfma_f32_16x16x32_bf16 v[48:51], v[144:147], v[168:171], v[48:51]
    v_mfma_f32_16x16x32_bf16 v[48:51], v[160:163], v[148:151], v[48:51]
    s_nop 0
    v_cvt_pk_bf16_f32 v64, v84, v88
    v_cvt_pk_bf16_f32 v65, v85, v89
    v_mfma_f32_16x16x32_bf16 v[32:35], v[188:191], v[180:183], v[32:35]
    v_cvt_pk_bf16_f32 v66, v86, v90
    v_cvt_pk_bf16_f32 v67, v87, v91
    v_mfma_f32_16x16x32_bf16 v[36:39], v[188:191], v[184:187], v[36:39]
    v_mfma_f32_16x16x32_bf16 v[40:43], v[188:191], v[192:195], v[40:43]
    ds_read_b128 v[76:79], v117 offset:8304
    s_waitcnt lgkmcnt(9)
    v_mfma_f32_16x16x32_bf16 v[52:55], v[204:207], v[244:247], 0
    ds_read_b128 v[80:83], v117 offset:8704
    v_mfma_f32_16x16x32_bf16 v[20:23], v[208:211], v[216:219], v[20:23]
    ds_read_b128 v[136:139], v117 offset:9216
    v_mfma_f32_16x16x32_bf16 v[56:59], v[204:207], v[248:251], 0
    ds_read2_b32 v[124:125], v114 offset0:192 offset1:193
    s_waitcnt lgkmcnt(9)
    v_mfma_f32_16x16x32_bf16 v[24:27], v[208:211], v[220:223], v[24:27]
    ds_read2_b32 v[126:127], v114 offset0:194 offset1:195
    v_mfma_f32_16x16x32_bf16 v[24:27], v[224:227], v[216:219], v[24:27]
    ds_read_b128 v[172:175], v117 offset:5504
    s_waitcnt lgkmcnt(10)
    v_mfma_f32_16x16x32_bf16 v[28:31], v[208:211], v[228:231], v[28:31]
    ds_read2_b32 v[128:129], v114 offset0:160 offset1:161
    v_mfma_f32_16x16x32_bf16 v[28:31], v[224:227], v[220:223], v[28:31]
    ds_read2_b32 v[130:131], v114 offset0:162 offset1:163
    s_waitcnt lgkmcnt(10)
    v_mfma_f32_16x16x32_bf16 v[84:87], v[232:235], v[244:247], 0
    ds_read_b128 v[156:159], v117 offset:5376
    v_cvt_pk_bf16_f32 v152, v52, v56
    v_mfma_f32_16x16x32_bf16 v[32:35], v[208:211], v[60:63], v[32:35]
    ds_read_b128 v[164:167], v117 offset:6016
    v_cvt_pk_bf16_f32 v153, v53, v57
    v_mfma_f32_16x16x32_bf16 v[88:91], v[232:235], v[248:251], 0
    v_cvt_pk_bf16_f32 v154, v54, v58
    v_cvt_pk_bf16_f32 v155, v55, v59
    v_mfma_f32_16x16x32_bf16 v[32:35], v[224:227], v[228:231], v[32:35]
    ds_read2_b32 v[196:197], v114 offset0:64 offset1:65
    s_waitcnt lgkmcnt(12)
    v_mfma_f32_16x16x32_bf16 v[36:39], v[208:211], v[68:71], v[36:39]
    v_mfma_f32_16x16x32_bf16 v[36:39], v[224:227], v[60:63], v[36:39]
    ds_read2_b32 v[198:199], v114 offset0:66 offset1:67
    s_waitcnt lgkmcnt(12)
    v_mfma_f32_16x16x32_bf16 v[40:43], v[208:211], v[72:75], v[40:43]
    v_cvt_pk_bf16_f32 v140, v84, v88
    v_cvt_pk_bf16_f32 v141, v85, v89
    v_mfma_f32_16x16x32_bf16 v[36:39], v[64:67], v[180:183], v[36:39]
    v_cvt_pk_bf16_f32 v142, v86, v90
    v_cvt_pk_bf16_f32 v143, v87, v91
    v_mfma_f32_16x16x32_bf16 v[40:43], v[64:67], v[184:187], v[40:43]
    ds_read_b128 v[120:123], v117 offset:5888
    s_waitcnt lgkmcnt(12)
    v_mfma_f32_16x16x32_bf16 v[52:55], v[76:79], v[244:247], 0
    v_mfma_f32_16x16x32_bf16 v[40:43], v[224:227], v[68:71], v[40:43]
    v_mfma_f32_16x16x32_bf16 v[56:59], v[76:79], v[248:251], 0
    ds_read2_b32 v[132:133], v114 offset0:32 offset1:33
    s_waitcnt lgkmcnt(12)
    v_mfma_f32_16x16x32_bf16 v[44:47], v[208:211], v[80:83], v[44:47]
    v_mfma_f32_16x16x32_bf16 v[44:47], v[224:227], v[72:75], v[44:47]
    ds_read2_b32 v[134:135], v114 offset0:34 offset1:35
    s_waitcnt lgkmcnt(12)
    v_mfma_f32_16x16x32_bf16 v[48:51], v[208:211], v[136:139], v[48:51]
    v_mfma_f32_16x16x32_bf16 v[48:51], v[224:227], v[80:83], v[48:51]
    v_cvt_pk_bf16_f32 v200, v52, v56
    v_cvt_pk_bf16_f32 v201, v53, v57
    v_mfma_f32_16x16x32_bf16 v[40:43], v[152:155], v[180:183], v[40:43]
    ds_read_b128 v[176:179], v117 offset:6528
    s_waitcnt lgkmcnt(10)
    v_mfma_f32_16x16x32_bf16 v[20:23], v[124:127], v[172:175], v[20:23]
    ds_read_b128 v[144:147], v117 offset:6400
    s_waitcnt lgkmcnt(8)
    v_mfma_f32_16x16x32_bf16 v[20:23], v[128:131], v[156:159], v[20:23]
    ds_read_b128 v[168:171], v117 offset:7040
    s_waitcnt lgkmcnt(8)
    v_mfma_f32_16x16x32_bf16 v[24:27], v[124:127], v[164:167], v[24:27]
    ds_read_b128 v[160:163], v117 offset:6912
    s_waitcnt lgkmcnt(7)
    v_mfma_f32_16x16x32_bf16 v[24:27], v[196:199], v[172:175], v[24:27]
    ds_read_b128 v[148:151], v117 offset:7552
    s_waitcnt lgkmcnt(7)
    v_mfma_f32_16x16x32_bf16 v[24:27], v[128:131], v[120:123], v[24:27]
    ds_read_b128 v[188:191], v117 offset:7424
    s_waitcnt lgkmcnt(6)
    v_mfma_f32_16x16x32_bf16 v[24:27], v[132:135], v[156:159], v[24:27]
    ds_write_b128 v119, v[20:23] offset:0
    s_waitcnt lgkmcnt(6)
    v_mfma_f32_16x16x32_bf16 v[28:31], v[124:127], v[176:179], v[28:31]
    v_cvt_pk_bf16_f32 v202, v54, v58
    v_cvt_pk_bf16_f32 v203, v55, v59
    v_mfma_f32_16x16x32_bf16 v[28:31], v[196:199], v[164:167], v[28:31]
    s_waitcnt lgkmcnt(5)
    v_mfma_f32_16x16x32_bf16 v[28:31], v[128:131], v[144:147], v[28:31]
    ds_read_b128 v[204:207], v117 offset:8064
    ds_read_b128 v[216:219], v117 offset:7936
    v_mfma_f32_16x16x32_bf16 v[28:31], v[132:135], v[120:123], v[28:31]
    ds_write_b128 v119, v[24:27] offset:1024
    s_waitcnt lgkmcnt(7)
    v_mfma_f32_16x16x32_bf16 v[32:35], v[124:127], v[168:171], v[32:35]
    v_mfma_f32_16x16x32_bf16 v[32:35], v[196:199], v[176:179], v[32:35]
    s_waitcnt lgkmcnt(6)
    v_mfma_f32_16x16x32_bf16 v[32:35], v[128:131], v[160:163], v[32:35]
    ds_read_b128 v[220:223], v117 offset:8576
    ds_read_b128 v[232:235], v117 offset:8448
    v_mfma_f32_16x16x32_bf16 v[32:35], v[132:135], v[144:147], v[32:35]
    ds_write_b128 v119, v[28:31] offset:2048
    s_waitcnt lgkmcnt(8)
    v_mfma_f32_16x16x32_bf16 v[36:39], v[124:127], v[148:151], v[36:39]
    v_mfma_f32_16x16x32_bf16 v[36:39], v[196:199], v[168:171], v[36:39]
    s_waitcnt lgkmcnt(7)
    v_mfma_f32_16x16x32_bf16 v[36:39], v[128:131], v[188:191], v[36:39]
    ds_read2_b32 v[228:229], v118 offset0:3 offset1:2
    ds_read2_b32 v[230:231], v118 offset0:1 offset1:0
    v_mfma_f32_16x16x32_bf16 v[36:39], v[132:135], v[160:163], v[36:39]
    ds_write_b128 v119, v[32:35] offset:3072
    s_waitcnt lgkmcnt(8)
    v_mfma_f32_16x16x32_bf16 v[40:43], v[124:127], v[204:207], v[40:43]
    v_mfma_f32_16x16x32_bf16 v[40:43], v[196:199], v[148:151], v[40:43]
    s_waitcnt lgkmcnt(7)
    v_mfma_f32_16x16x32_bf16 v[40:43], v[128:131], v[216:219], v[40:43]
    ds_read_b128 v[60:63], v117 offset:9088
    ds_read_b128 v[68:71], v117 offset:8960
    v_mfma_f32_16x16x32_bf16 v[40:43], v[132:135], v[188:191], v[40:43]
    ds_write_b128 v119, v[36:39] offset:4096
    s_waitcnt lgkmcnt(8)
    v_mfma_f32_16x16x32_bf16 v[44:47], v[124:127], v[220:223], v[44:47]
    v_mfma_f32_16x16x32_bf16 v[44:47], v[196:199], v[204:207], v[44:47]
    s_waitcnt lgkmcnt(7)
    v_mfma_f32_16x16x32_bf16 v[44:47], v[128:131], v[232:235], v[44:47]
    ds_read2_b32 v[76:77], v118 offset0:19 offset1:18
    ds_read2_b32 v[78:79], v118 offset0:17 offset1:16
    v_mfma_f32_16x16x32_bf16 v[44:47], v[132:135], v[216:219], v[44:47]
    ds_write_b128 v119, v[40:43] offset:5120
    s_waitcnt lgkmcnt(7)
    v_mfma_f32_16x16x32_bf16 v[44:47], v[212:215], v[228:231], v[44:47]
    v_mfma_f32_16x16x32_bf16 v[44:47], v[64:67], v[192:195], v[44:47]
    v_mfma_f32_16x16x32_bf16 v[44:47], v[152:155], v[184:187], v[44:47]
    v_mfma_f32_16x16x32_bf16 v[44:47], v[140:143], v[180:183], v[44:47]
    s_waitcnt lgkmcnt(5)
    v_mfma_f32_16x16x32_bf16 v[48:51], v[124:127], v[60:63], v[48:51]
    v_mfma_f32_16x16x32_bf16 v[48:51], v[196:199], v[220:223], v[48:51]
    s_waitcnt lgkmcnt(4)
    v_mfma_f32_16x16x32_bf16 v[48:51], v[128:131], v[68:71], v[48:51]
    v_mfma_f32_16x16x32_bf16 v[48:51], v[132:135], v[232:235], v[48:51]
    s_nop 1
    ds_write_b128 v119, v[44:47] offset:6144
    s_waitcnt lgkmcnt(2)
    v_mfma_f32_16x16x32_bf16 v[48:51], v[212:215], v[76:79], v[48:51]
    v_mfma_f32_16x16x32_bf16 v[48:51], v[152:155], v[192:195], v[48:51]
    v_mfma_f32_16x16x32_bf16 v[48:51], v[140:143], v[184:187], v[48:51]
    v_mfma_f32_16x16x32_bf16 v[48:51], v[200:203], v[180:183], v[48:51]
    s_nop 7
    ds_write_b128 v119, v[48:51] offset:7168
    s_waitcnt lgkmcnt(0)
    s_barrier
    ds_read_b128 v[20:23], v113 offset:0
    ds_read_b128 v[24:27], v113 offset:256
    ds_read_b128 v[28:31], v113 offset:8192
    ds_read_b128 v[32:35], v113 offset:8448
    s_waitcnt lgkmcnt(1)
    v_pk_add_f32 v[20:21], v[20:21], v[28:29]
    v_pk_add_f32 v[22:23], v[22:23], v[30:31]
    s_waitcnt lgkmcnt(0)
    v_pk_add_f32 v[24:25], v[24:25], v[32:33]
    v_pk_add_f32 v[26:27], v[26:27], v[34:35]
    v_cvt_pk_bf16_f32 v44, v20, v21
    v_cvt_pk_bf16_f32 v45, v22, v23
    v_cvt_pk_bf16_f32 v46, v24, v25
    v_cvt_pk_bf16_f32 v47, v26, v27
    global_store_dwordx4 v7, v[44:47], s[22:23] offset:0 sc1
    s_branch L_prep
L_helper:
    s_cmp_lg_u32 s3, 7
    s_cbranch_scc1 L_noclr
    s_mov_b64 exec, 1
    global_store_dwordx4 v55, v[56:59], s[34:35] sc1
    s_mov_b64 exec, -1
L_noclr:
    global_load_dword v9, v91, s[100:101]

    s_or_b32 s44, s2, s40
    s_cmp_lg_u32 s44, 0
    s_cbranch_scc1 L_noE
    v_not_b32 v28, s36
    v_not_b32 v29, s37
    v_not_b32 v30, s38
    v_not_b32 v31, s39
    v_mov_b32 v32, 0
    s_mov_b64 exec, 1
    global_store_dwordx4 v32, v[28:31], s[34:35] sc1
    s_mov_b64 exec, -1
L_noE:

    s_nop 0
    ds_read_b64_tr_b16 v[60:61], v19
    ds_read_b64_tr_b16 v[62:63], v19 offset:3840
    ds_read_b64_tr_b16 v[64:65], v19 offset:7680
    ds_read_b64_tr_b16 v[66:67], v19 offset:11520
    v_lshrrev_b32 v52, 1, v0
    v_and_b32 v53, 16, v6
    v_lshlrev_b32 v52, 13, v52
    s_lshl_b32 s44, s6, 5
    v_add3_u32 v253, v52, v53, s44
    v_mov_b32 v53, 1839104
    s_mul_i32 s44, s6, 7168
    s_add_u32 s44, s44, 3584
    v_add_u32_e64 v254, s44, v254
    s_mov_b32 s45, 570434048
    s_movk_i32 s46, 0x3f80
    s_mov_b32 s47, 0x3f800000
    v_lshlrev_b32 v40, 16, v255
    v_add_f32 v40, 1.0, v40
    s_waitcnt lgkmcnt(0)

    v_add_u32 v64, s45, v64
    v_lshlrev_b32 v70, 16, v60
    v_and_b32 v71, s96, v60
    v_add_u32 v65, s45, v65
    v_lshlrev_b32 v72, 16, v61
    v_and_b32 v73, s96, v61
    v_add_u32 v66, s45, v66
    v_lshlrev_b32 v74, 16, v62
    v_and_b32 v75, s96, v62
    v_add_u32 v67, s45, v67
    v_lshlrev_b32 v76, 16, v63
    v_and_b32 v77, s96, v63
    v_lshlrev_b32 v80, 16, v64
    v_and_b32 v81, s96, v64
    v_lshlrev_b32 v82, 16, v65
    v_and_b32 v83, s96, v65
    v_lshlrev_b32 v84, 16, v66
    v_and_b32 v85, s96, v66
    v_lshlrev_b32 v86, 16, v67
    v_and_b32_e64 v87, s96, v67
    v_pk_fma_f32 v[70:71], v[80:81], v[40:41], v[70:71] op_sel_hi:[1,0,1]
    v_pk_fma_f32 v[72:73], v[82:83], v[40:41], v[72:73] op_sel_hi:[1,0,1]
    v_pk_fma_f32 v[74:75], v[84:85], v[40:41], v[74:75] op_sel_hi:[1,0,1]
    v_pk_fma_f32 v[76:77], v[86:87], v[40:41], v[76:77] op_sel_hi:[1,0,1]
    s_setprio 2
    s_barrier
    ds_read_b128 v[20:23], v113 offset:0
    ds_read_b128 v[24:27], v113 offset:256
    ds_read_b128 v[28:31], v113 offset:8192
    ds_read_b128 v[32:35], v113 offset:8448
    s_waitcnt lgkmcnt(1)
    v_pk_add_f32 v[20:21], v[20:21], v[28:29]
    v_pk_add_f32 v[22:23], v[22:23], v[30:31]
    s_waitcnt lgkmcnt(0)
    v_pk_add_f32 v[24:25], v[24:25], v[32:33]
    v_pk_add_f32 v[26:27], v[26:27], v[34:35]
    v_cvt_pk_bf16_f32 v44, v20, v21
    v_cvt_pk_bf16_f32 v45, v22, v23
    v_cvt_pk_bf16_f32 v46, v24, v25
    v_cvt_pk_bf16_f32 v47, v26, v27
    global_store_dwordx4 v7, v[44:47], s[22:23] offset:0 sc1
    s_cmp_lg_u32 s3, 7
    s_cbranch_scc1 L_pidc
    s_mov_b32 s50, 0
L_pic:
    global_load_dword v24, v53, s[22:23] sc1
    s_add_u32 s50, s50, 1
    s_waitcnt vmcnt(0)
    v_cmp_eq_u32 vcc, -1, v24
    s_cmp_ge_u32 s50, 200000
    s_cbranch_scc1 L_pidc
    s_cbranch_vccnz L_pic
L_pidc:
    s_waitcnt vmcnt(0)
    s_barrier
    s_cmp_lg_u32 s3, 7
    s_cbranch_scc1 L_epi2
    s_endpgm
    .p2align 12
L_t1:
    s_branch L_t1r
L_ty1:

    s_nop 0
    s_waitcnt lgkmcnt(0)
    s_barrier
    ds_read2_b32 v[120:121], v114 offset0:240 offset1:241
    ds_read2_b32 v[122:123], v114 offset0:242 offset1:243
    ds_read_b128 v[124:127], v117 offset:5696
    ds_read_b128 v[128:131], v117 offset:6208
    ds_read2_b32 v[132:133], v114 offset0:112 offset1:113
    ds_read2_b32 v[134:135], v114 offset0:114 offset1:115
    ds_read_b128 v[136:139], v117 offset:5728
    ds_read_b128 v[140:143], v117 offset:6720
    ds_read_b128 v[144:147], v117 offset:7232
    ds_read_b128 v[148:151], v117 offset:6240
    s_waitcnt lgkmcnt(7)
    v_mfma_f32_16x16x32_bf16 v[20:23], v[120:123], v[124:127], 0
    ds_read_b128 v[152:155], v117 offset:7744
    s_waitcnt lgkmcnt(7)
    v_mfma_f32_16x16x32_bf16 v[24:27], v[120:123], v[128:131], 0
    ds_read_b64 v[156:157], v117 offset:5736
    s_waitcnt lgkmcnt(6)
    v_mfma_f32_16x16x32_bf16 v[24:27], v[132:135], v[124:127], v[24:27]
    ds_read_b64 v[158:159], v117 offset:5744
    s_waitcnt lgkmcnt(6)
    v_mfma_f32_16x16x32_bf16 v[52:55], v[136:139], v[244:247], 0
    ds_read_b128 v[160:163], v117 offset:8256
    s_waitcnt lgkmcnt(6)
    v_mfma_f32_16x16x32_bf16 v[28:31], v[120:123], v[140:143], 0
    ds_read_b128 v[164:167], v117 offset:8768
    v_mfma_f32_16x16x32_bf16 v[56:59], v[136:139], v[248:251], 0
    ds_read2_b32 v[172:173], v112 offset0:6 offset1:4
    v_mfma_f32_16x16x32_bf16 v[28:31], v[132:135], v[128:131], v[28:31]
    ds_read2_b32 v[174:175], v112 offset0:2 offset1:0
    s_waitcnt lgkmcnt(8)
    v_mfma_f32_16x16x32_bf16 v[32:35], v[120:123], v[144:147], 0
    ds_read2_b32 v[176:177], v112 offset0:38 offset1:36
    s_waitcnt lgkmcnt(8)
    v_mfma_f32_16x16x32_bf16 v[84:87], v[148:151], v[244:247], 0
    ds_read2_b32 v[178:179], v112 offset0:34 offset1:32
    v_mfma_f32_16x16x32_bf16 v[32:35], v[132:135], v[140:143], v[32:35]
    ds_read2_b32 v[180:181], v112 offset0:70 offset1:68
    v_cvt_pk_bf16_f32 v168, v52, v56
    v_mfma_f32_16x16x32_bf16 v[88:91], v[148:151], v[248:251], 0
    ds_read2_b32 v[182:183], v112 offset0:66 offset1:64
    s_waitcnt lgkmcnt(10)
    v_mfma_f32_16x16x32_bf16 v[36:39], v[120:123], v[152:155], 0
    ds_read_b128 v[188:191], v117 offset:6752
    v_cvt_pk_bf16_f32 v169, v53, v57
    v_mfma_f32_16x16x32_bf16 v[36:39], v[132:135], v[144:147], v[36:39]
    ds_read_b128 v[192:195], v117 offset:9280
    s_waitcnt lgkmcnt(9)
    v_cvt_pk_bf16_f32 v170, v54, v58
    v_cvt_pk_bf16_f32 v171, v55, v59
    v_mfma_f32_16x16x32_bf16 v[52:55], v[156:159], v[236:239], 0
    ds_read_b128 v[196:199], v117 offset:7264
    v_mfma_f32_16x16x32_bf16 v[40:43], v[120:123], v[160:163], 0
    ds_read2_b32 v[200:201], v114 offset0:208 offset1:209
    v_cvt_pk_bf16_f32 v184, v84, v88
    v_mfma_f32_16x16x32_bf16 v[56:59], v[156:159], v[240:243], 0
    ds_read2_b32 v[202:203], v114 offset0:210 offset1:211
    v_cvt_pk_bf16_f32 v185, v85, v89
    v_mfma_f32_16x16x32_bf16 v[40:43], v[132:135], v[152:155], v[40:43]
    ds_read_b128 v[208:211], v117 offset:5568
    s_waitcnt lgkmcnt(10)
    v_mfma_f32_16x16x32_bf16 v[44:47], v[120:123], v[164:167], 0
    ds_read_b128 v[212:215], v117 offset:6080
    v_cvt_pk_bf16_f32 v186, v86, v90
    v_mfma_f32_16x16x32_bf16 v[28:31], v[168:171], v[172:175], v[28:31]
    ds_read2_b32 v[216:217], v114 offset0:80 offset1:81
    s_waitcnt lgkmcnt(8)
    v_mfma_f32_16x16x32_bf16 v[32:35], v[168:171], v[176:179], v[32:35]
    ds_read2_b32 v[218:219], v114 offset0:82 offset1:83
    v_cvt_pk_bf16_f32 v187, v87, v91
    v_mfma_f32_16x16x32_bf16 v[36:39], v[168:171], v[180:183], v[36:39]
    ds_read2_b32 v[220:221], v118 offset0:3 offset1:2
    s_waitcnt lgkmcnt(9)
    v_mfma_f32_16x16x32_bf16 v[84:87], v[188:191], v[244:247], 0
    ds_read2_b32 v[222:223], v118 offset0:1 offset1:0
    v_cvt_pk_bf16_f32 v204, v52, v56
    v_mfma_f32_16x16x32_bf16 v[44:47], v[132:135], v[160:163], v[44:47]
    ds_read2_b32 v[224:225], v118 offset0:19 offset1:18
    v_cvt_pk_bf16_f32 v205, v53, v57
    v_mfma_f32_16x16x32_bf16 v[88:91], v[188:191], v[248:251], 0
    ds_read2_b32 v[226:227], v118 offset0:17 offset1:16
    s_waitcnt lgkmcnt(11)
    v_mfma_f32_16x16x32_bf16 v[48:51], v[120:123], v[192:195], 0
    ds_read_b64 v[232:233], v117 offset:6248
    v_cvt_pk_bf16_f32 v206, v54, v58
    v_mfma_f32_16x16x32_bf16 v[48:51], v[132:135], v[164:167], v[48:51]
    v_cvt_pk_bf16_f32 v207, v55, v59
    v_mfma_f32_16x16x32_bf16 v[32:35], v[184:187], v[172:175], v[32:35]
    v_mfma_f32_16x16x32_bf16 v[36:39], v[184:187], v[176:179], v[36:39]
    v_cvt_pk_bf16_f32 v228, v84, v88
    v_cvt_pk_bf16_f32 v229, v85, v89
    v_mfma_f32_16x16x32_bf16 v[40:43], v[184:187], v[180:183], v[40:43]
    ds_read_b64 v[234:235], v117 offset:6256
    s_waitcnt lgkmcnt(9)
    v_mfma_f32_16x16x32_bf16 v[52:55], v[196:199], v[244:247], 0
    ds_read_b128 v[60:63], v117 offset:6592
    v_cvt_pk_bf16_f32 v230, v86, v90
    v_mfma_f32_16x16x32_bf16 v[20:23], v[200:203], v[208:211], v[20:23]
    ds_read_b128 v[64:67], v117 offset:7104
    v_cvt_pk_bf16_f32 v231, v87, v91
    v_mfma_f32_16x16x32_bf16 v[56:59], v[196:199], v[248:251], 0
    ds_read_b128 v[72:75], v117 offset:7776
    s_waitcnt lgkmcnt(9)
    v_mfma_f32_16x16x32_bf16 v[24:27], v[200:203], v[212:215], v[24:27]
    ds_read_b128 v[76:79], v117 offset:7616
    v_mfma_f32_16x16x32_bf16 v[24:27], v[216:219], v[208:211], v[24:27]
    ds_read_b128 v[80:83], v117 offset:8288
    s_waitcnt lgkmcnt(9)
    v_mfma_f32_16x16x32_bf16 v[36:39], v[204:207], v[220:223], v[36:39]
    ds_read_b128 v[124:127], v117 offset:8128
    s_waitcnt lgkmcnt(8)
    v_mfma_f32_16x16x32_bf16 v[40:43], v[204:207], v[224:227], v[40:43]
    ds_read_b128 v[136:139], v117 offset:8640
    s_waitcnt lgkmcnt(7)
    v_mfma_f32_16x16x32_bf16 v[84:87], v[232:235], v[236:239], 0
    ds_read_b64 v[128:129], v117 offset:7272
    s_waitcnt lgkmcnt(7)
    v_mfma_f32_16x16x32_bf16 v[28:31], v[200:203], v[60:63], v[28:31]
    ds_read_b64 v[130:131], v117 offset:7280
    v_cvt_pk_bf16_f32 v68, v52, v56
    v_mfma_f32_16x16x32_bf16 v[88:91], v[232:235], v[240:243], 0
    ds_read_b128 v[148:151], v117 offset:9152
    v_cvt_pk_bf16_f32 v69, v53, v57
    v_mfma_f32_16x16x32_bf16 v[28:31], v[216:219], v[212:215], v[28:31]
    ds_read2_b32 v[144:145], v114 offset0:176 offset1:177
    s_waitcnt lgkmcnt(9)
    v_mfma_f32_16x16x32_bf16 v[32:35], v[200:203], v[64:67], v[32:35]
    ds_read2_b32 v[146:147], v114 offset0:178 offset1:179
    v_cvt_pk_bf16_f32 v70, v54, v58
    v_mfma_f32_16x16x32_bf16 v[36:39], v[228:231], v[172:175], v[36:39]
    ds_read_b128 v[156:159], v117 offset:5440
    v_cvt_pk_bf16_f32 v71, v55, v59
    v_mfma_f32_16x16x32_bf16 v[40:43], v[228:231], v[176:179], v[40:43]
    ds_read2_b32 v[152:153], v114 offset0:144 offset1:145
    s_waitcnt lgkmcnt(11)
    v_mfma_f32_16x16x32_bf16 v[52:55], v[72:75], v[244:247], 0
    ds_read2_b32 v[154:155], v114 offset0:146 offset1:147
    v_cvt_pk_bf16_f32 v140, v84, v88
    v_mfma_f32_16x16x32_bf16 v[32:35], v[216:219], v[60:63], v[32:35]
    v_cvt_pk_bf16_f32 v141, v85, v89
    v_cvt_pk_bf16_f32 v142, v86, v90
    v_mfma_f32_16x16x32_bf16 v[56:59], v[72:75], v[248:251], 0
    ds_read_b128 v[160:163], v117 offset:5312
    s_waitcnt lgkmcnt(12)
    v_mfma_f32_16x16x32_bf16 v[36:39], v[200:203], v[76:79], v[36:39]
    v_cvt_pk_bf16_f32 v143, v87, v91
    v_mfma_f32_16x16x32_bf16 v[36:39], v[216:219], v[64:67], v[36:39]
    v_mfma_f32_16x16x32_bf16 v[40:43], v[68:71], v[172:175], v[40:43]
    ds_read_b128 v[188:191], v117 offset:5952
    s_waitcnt lgkmcnt(11)
    v_mfma_f32_16x16x32_bf16 v[84:87], v[80:83], v[244:247], 0
    ds_read2_b32 v[120:121], v114 offset0:48 offset1:49
    v_cvt_pk_bf16_f32 v168, v52, v56
    v_mfma_f32_16x16x32_bf16 v[40:43], v[200:203], v[124:127], v[40:43]
    v_cvt_pk_bf16_f32 v169, v53, v57
    v_cvt_pk_bf16_f32 v170, v54, v58
    v_mfma_f32_16x16x32_bf16 v[88:91], v[80:83], v[248:251], 0
    v_cvt_pk_bf16_f32 v171, v55, v59
    v_mfma_f32_16x16x32_bf16 v[40:43], v[216:219], v[76:79], v[40:43]
    ds_read2_b32 v[122:123], v114 offset0:50 offset1:51
    s_waitcnt lgkmcnt(12)
    v_mfma_f32_16x16x32_bf16 v[44:47], v[200:203], v[136:139], v[44:47]
    v_mfma_f32_16x16x32_bf16 v[40:43], v[140:143], v[220:223], v[40:43]
    ds_read_b128 v[132:135], v117 offset:5824
    s_waitcnt lgkmcnt(11)
    v_mfma_f32_16x16x32_bf16 v[52:55], v[128:131], v[236:239], 0
    ds_read2_b32 v[164:165], v114 offset0:16 offset1:17
    v_cvt_pk_bf16_f32 v192, v84, v88
    v_mfma_f32_16x16x32_bf16 v[44:47], v[216:219], v[124:127], v[44:47]
    v_cvt_pk_bf16_f32 v193, v85, v89
    v_cvt_pk_bf16_f32 v194, v86, v90
    v_mfma_f32_16x16x32_bf16 v[56:59], v[128:131], v[240:243], 0
    ds_read2_b32 v[166:167], v114 offset0:18 offset1:19
    s_waitcnt lgkmcnt(12)
    v_mfma_f32_16x16x32_bf16 v[48:51], v[200:203], v[148:151], v[48:51]
    v_cvt_pk_bf16_f32 v195, v87, v91
    v_mfma_f32_16x16x32_bf16 v[48:51], v[216:219], v[136:139], v[48:51]
    ds_read_b128 v[196:199], v117 offset:6464
    s_waitcnt lgkmcnt(10)
    v_mfma_f32_16x16x32_bf16 v[20:23], v[144:147], v[156:159], v[20:23]
    ds_read_b128 v[208:211], v117 offset:6336
    s_waitcnt lgkmcnt(8)
    v_mfma_f32_16x16x32_bf16 v[20:23], v[152:155], v[160:163], v[20:23]
    ds_read_b128 v[232:235], v117 offset:6976
    s_waitcnt lgkmcnt(8)
    v_mfma_f32_16x16x32_bf16 v[24:27], v[144:147], v[188:191], v[24:27]
    ds_read_b128 v[212:215], v117 offset:6848
    s_waitcnt lgkmcnt(7)
    v_mfma_f32_16x16x32_bf16 v[24:27], v[120:123], v[156:159], v[24:27]
    ds_read_b128 v[60:63], v117 offset:7488
    s_waitcnt lgkmcnt(7)
    v_mfma_f32_16x16x32_bf16 v[24:27], v[152:155], v[132:135], v[24:27]
    ds_read_b128 v[72:75], v117 offset:7360
    s_waitcnt lgkmcnt(6)
    v_mfma_f32_16x16x32_bf16 v[24:27], v[164:167], v[160:163], v[24:27]
    ds_write_b128 v119, v[20:23] offset:0
    s_waitcnt lgkmcnt(6)
    v_mfma_f32_16x16x32_bf16 v[28:31], v[144:147], v[196:199], v[28:31]
    v_cvt_pk_bf16_f32 v184, v52, v56
    v_cvt_pk_bf16_f32 v185, v53, v57
    v_mfma_f32_16x16x32_bf16 v[28:31], v[120:123], v[188:191], v[28:31]
    v_cvt_pk_bf16_f32 v186, v54, v58
    s_waitcnt lgkmcnt(5)
    v_mfma_f32_16x16x32_bf16 v[28:31], v[152:155], v[208:211], v[28:31]
    ds_read_b128 v[64:67], v117 offset:8000
    ds_read_b128 v[80:83], v117 offset:7872
    v_mfma_f32_16x16x32_bf16 v[28:31], v[164:167], v[132:135], v[28:31]
    ds_write_b128 v119, v[24:27] offset:1024
    s_waitcnt lgkmcnt(7)
    v_mfma_f32_16x16x32_bf16 v[32:35], v[144:147], v[232:235], v[32:35]
    v_cvt_pk_bf16_f32 v187, v55, v59
    v_mfma_f32_16x16x32_bf16 v[32:35], v[120:123], v[196:199], v[32:35]
    s_waitcnt lgkmcnt(6)
    v_mfma_f32_16x16x32_bf16 v[32:35], v[152:155], v[212:215], v[32:35]
    ds_read_b128 v[76:79], v117 offset:8512
    ds_read_b128 v[124:127], v117 offset:8384
    v_mfma_f32_16x16x32_bf16 v[32:35], v[164:167], v[208:211], v[32:35]
    ds_write_b128 v119, v[28:31] offset:2048
    s_waitcnt lgkmcnt(8)
    v_mfma_f32_16x16x32_bf16 v[36:39], v[144:147], v[60:63], v[36:39]
    v_mfma_f32_16x16x32_bf16 v[36:39], v[120:123], v[232:235], v[36:39]
    s_waitcnt lgkmcnt(7)
    v_mfma_f32_16x16x32_bf16 v[36:39], v[152:155], v[72:75], v[36:39]
    ds_read2_b32 v[128:129], v118 offset0:35 offset1:34
    ds_read2_b32 v[130:131], v118 offset0:33 offset1:32
    v_mfma_f32_16x16x32_bf16 v[36:39], v[164:167], v[212:215], v[36:39]
    ds_write_b128 v119, v[32:35] offset:3072
    s_waitcnt lgkmcnt(8)
    v_mfma_f32_16x16x32_bf16 v[40:43], v[144:147], v[64:67], v[40:43]
    v_mfma_f32_16x16x32_bf16 v[40:43], v[120:123], v[60:63], v[40:43]
    s_waitcnt lgkmcnt(7)
    v_mfma_f32_16x16x32_bf16 v[40:43], v[152:155], v[80:83], v[40:43]
    ds_read_b128 v[200:203], v117 offset:9024
    ds_read_b128 v[148:151], v117 offset:8896
    v_mfma_f32_16x16x32_bf16 v[40:43], v[164:167], v[72:75], v[40:43]
    ds_write_b128 v119, v[36:39] offset:4096
    s_waitcnt lgkmcnt(8)
    v_mfma_f32_16x16x32_bf16 v[44:47], v[144:147], v[76:79], v[44:47]
    v_mfma_f32_16x16x32_bf16 v[44:47], v[120:123], v[64:67], v[44:47]
    s_waitcnt lgkmcnt(7)
    v_mfma_f32_16x16x32_bf16 v[44:47], v[152:155], v[124:127], v[44:47]
    ds_read2_b32 v[216:217], v118 offset0:51 offset1:50
    ds_read2_b32 v[218:219], v118 offset0:49 offset1:48
    v_mfma_f32_16x16x32_bf16 v[44:47], v[164:167], v[80:83], v[44:47]
    ds_write_b128 v119, v[40:43] offset:5120
    s_waitcnt lgkmcnt(7)
    v_mfma_f32_16x16x32_bf16 v[44:47], v[204:207], v[128:131], v[44:47]
    v_mfma_f32_16x16x32_bf16 v[44:47], v[228:231], v[180:183], v[44:47]
    v_mfma_f32_16x16x32_bf16 v[44:47], v[68:71], v[176:179], v[44:47]
    v_mfma_f32_16x16x32_bf16 v[44:47], v[140:143], v[224:227], v[44:47]
    v_mfma_f32_16x16x32_bf16 v[44:47], v[168:171], v[172:175], v[44:47]
    s_waitcnt lgkmcnt(5)
    v_mfma_f32_16x16x32_bf16 v[48:51], v[144:147], v[200:203], v[48:51]
    v_mfma_f32_16x16x32_bf16 v[48:51], v[120:123], v[76:79], v[48:51]
    s_waitcnt lgkmcnt(4)
    v_mfma_f32_16x16x32_bf16 v[48:51], v[152:155], v[148:151], v[48:51]
    v_mfma_f32_16x16x32_bf16 v[48:51], v[164:167], v[124:127], v[48:51]
    s_nop 1
    ds_write_b128 v119, v[44:47] offset:6144
    s_waitcnt lgkmcnt(2)
    v_mfma_f32_16x16x32_bf16 v[48:51], v[204:207], v[216:219], v[48:51]
    v_mfma_f32_16x16x32_bf16 v[48:51], v[68:71], v[180:183], v[48:51]
    v_mfma_f32_16x16x32_bf16 v[48:51], v[140:143], v[128:131], v[48:51]
    v_mfma_f32_16x16x32_bf16 v[48:51], v[168:171], v[176:179], v[48:51]
    v_mfma_f32_16x16x32_bf16 v[48:51], v[192:195], v[172:175], v[48:51]
    v_mfma_f32_16x16x32_bf16 v[48:51], v[184:187], v[220:223], v[48:51]
    s_nop 7
    ds_write_b128 v119, v[48:51] offset:7168
    s_waitcnt lgkmcnt(0)
    s_barrier
    ds_read_b128 v[20:23], v113 offset:0
    ds_read_b128 v[24:27], v113 offset:256
    ds_read_b128 v[28:31], v113 offset:8192
    ds_read_b128 v[32:35], v113 offset:8448
    s_waitcnt lgkmcnt(1)
    v_pk_add_f32 v[20:21], v[20:21], v[28:29]
    v_pk_add_f32 v[22:23], v[22:23], v[30:31]
    s_waitcnt lgkmcnt(0)
    v_pk_add_f32 v[24:25], v[24:25], v[32:33]
    v_pk_add_f32 v[26:27], v[26:27], v[34:35]
    v_cvt_pk_bf16_f32 v44, v20, v21
    v_cvt_pk_bf16_f32 v45, v22, v23
    v_cvt_pk_bf16_f32 v46, v24, v25
    v_cvt_pk_bf16_f32 v47, v26, v27
    global_store_dwordx4 v7, v[44:47], s[22:23] offset:0 sc1
L_prep:
    ds_read_b64_tr_b16 v[60:61], v19
    ds_read_b64_tr_b16 v[62:63], v19 offset:3840
    ds_read_b64_tr_b16 v[64:65], v19 offset:7680
    ds_read_b64_tr_b16 v[66:67], v19 offset:11520
    v_lshrrev_b32 v52, 1, v0
    v_and_b32 v53, 16, v6
    v_lshlrev_b32 v52, 13, v52
    s_lshl_b32 s44, s6, 5
    v_add3_u32 v253, v52, v53, s44
    v_mov_b32 v53, 1839104
    s_mul_i32 s44, s6, 7168
    s_add_u32 s44, s44, 3584
    v_add_u32_e64 v254, s44, v254
    s_mov_b32 s45, 570434048
    s_movk_i32 s46, 0x3f80
    s_mov_b32 s47, 0x3f800000
    v_lshlrev_b32 v40, 16, v255
    v_add_f32 v40, 1.0, v40
    s_waitcnt lgkmcnt(0)

    v_add_u32 v64, s45, v64
    v_lshlrev_b32 v70, 16, v60
    v_and_b32 v71, s96, v60
    v_add_u32 v65, s45, v65
    v_lshlrev_b32 v72, 16, v61
    v_and_b32 v73, s96, v61
    v_add_u32 v66, s45, v66
    v_lshlrev_b32 v74, 16, v62
    v_and_b32 v75, s96, v62
    v_add_u32 v67, s45, v67
    v_lshlrev_b32 v76, 16, v63
    v_and_b32 v77, s96, v63
    v_lshlrev_b32 v80, 16, v64
    v_and_b32 v81, s96, v64
    v_lshlrev_b32 v82, 16, v65
    v_and_b32 v83, s96, v65
    v_lshlrev_b32 v84, 16, v66
    v_and_b32 v85, s96, v66
    v_lshlrev_b32 v86, 16, v67
    v_and_b32_e64 v87, s96, v67
    v_pk_fma_f32 v[70:71], v[80:81], v[40:41], v[70:71] op_sel_hi:[1,0,1]
    v_pk_fma_f32 v[72:73], v[82:83], v[40:41], v[72:73] op_sel_hi:[1,0,1]
    v_pk_fma_f32 v[74:75], v[84:85], v[40:41], v[74:75] op_sel_hi:[1,0,1]
    v_pk_fma_f32 v[76:77], v[86:87], v[40:41], v[76:77] op_sel_hi:[1,0,1]
L_bar3:
    s_waitcnt vmcnt(0)
    s_barrier

L_epi2:
    global_load_dwordx4 v[20:23], v253, s[22:23] sc1
    global_load_dword v24, v53, s[22:23] sc1
    s_mov_b32 s50, 0
L_poll2:
    s_waitcnt vmcnt(0)
    v_max3_u32 v25, v20, v21, v22
    v_max3_u32 v25, v25, v23, v24
    v_cmp_eq_u32_e64 vcc, -1, v25
    s_add_u32 s50, s50, 1
    s_cbranch_vccz L_poll2_done
    s_cmp_ge_u32 s50, 200000
    s_cbranch_scc1 L_poll2_done
    s_mov_b64 exec, vcc
    global_load_dwordx4 v[20:23], v253, s[22:23] sc1
    global_load_dword v24, v53, s[22:23] sc1
    s_branch L_poll2
L_poll2_done:
    s_mov_b64 exec, -1

    v_readfirstlane_b32 s49, v24
    v_dot2c_f32_bf16 v70, s46, v20
    v_dot2c_f32_bf16 v71, s47, v20
    v_dot2c_f32_bf16 v72, s46, v21
    v_dot2c_f32_bf16 v73, s47, v21
    v_dot2c_f32_bf16 v74, s46, v22
    v_dot2c_f32_bf16 v75, s47, v22
    v_dot2c_f32_bf16 v76, s46, v23
    v_dot2c_f32_bf16 v77, s47, v23
    s_lshr_b32 s44, s49, 3
    s_cmp_eq_u32 s44, s6
    s_cbranch_scc1 L_owner
    v_cvt_pk_bf16_f32 v20, v70, v71
    global_store_short v254, v20, s[32:33] offset:-3584 sc1
    global_store_short_d16_hi v254, v20, s[32:33] offset:-2688 sc1
    v_cvt_pk_bf16_f32 v21, v72, v73
    global_store_short v254, v21, s[32:33] offset:-1792 sc1
    global_store_short_d16_hi v254, v21, s[32:33] offset:-896 sc1
    v_cvt_pk_bf16_f32 v22, v74, v75
    global_store_short v254, v22, s[32:33] offset:0 sc1
    global_store_short_d16_hi v254, v22, s[32:33] offset:896 sc1
    v_cvt_pk_bf16_f32 v23, v76, v77
    global_store_short v254, v23, s[32:33] offset:1792 sc1
    global_store_short_d16_hi v254, v23, s[32:33] offset:2688 sc1
    s_endpgm
L_owner:
    s_and_b32 s44, s49, 7
    v_cvt_pk_bf16_f32 v20, v70, v71
    v_cvt_pk_bf16_f32 v21, v72, v73
    v_cvt_pk_bf16_f32 v22, v74, v75
    v_cvt_pk_bf16_f32 v23, v76, v77
    s_cmp_eq_u32 s44, 0
    s_cbranch_scc1 L_sk0
    global_store_short v254, v20, s[32:33] offset:-3584 sc1
L_sk0:
    s_cmp_eq_u32 s44, 1
    s_cbranch_scc1 L_sk1
    global_store_short_d16_hi v254, v20, s[32:33] offset:-2688 sc1
L_sk1:
    s_cmp_eq_u32 s44, 2
    s_cbranch_scc1 L_sk2
    global_store_short v254, v21, s[32:33] offset:-1792 sc1
L_sk2:
    s_cmp_eq_u32 s44, 3
    s_cbranch_scc1 L_sk3
    global_store_short_d16_hi v254, v21, s[32:33] offset:-896 sc1
L_sk3:
    s_cmp_eq_u32 s44, 4
    s_cbranch_scc1 L_sk4
    global_store_short v254, v22, s[32:33] offset:0 sc1
L_sk4:
    s_cmp_eq_u32 s44, 5
    s_cbranch_scc1 L_sk5
    global_store_short_d16_hi v254, v22, s[32:33] offset:896 sc1
L_sk5:
    s_cmp_eq_u32 s44, 6
    s_cbranch_scc1 L_sk6
    global_store_short v254, v23, s[32:33] offset:1792 sc1
L_sk6:
    s_cmp_eq_u32 s44, 7
    s_cbranch_scc1 L_sk7
    global_store_short_d16_hi v254, v23, s[32:33] offset:2688 sc1
L_sk7:
    s_endpgm
    .p2align 12
L_t2:
    s_branch L_t2r
L_pubf0:
    s_cmp_lg_u32 s43, 0
    s_cbranch_scc1 L_pw
    s_waitcnt vmcnt(5)
L_pw:
    s_waitcnt vmcnt(5) lgkmcnt(0)
    s_waitcnt vmcnt(4)
    s_barrier
    s_cmp_eq_u32 s3, 7
    s_cbranch_scc1 L_candf
    ds_read_b64_tr_b16 v[20:21], v19 offset:7680
    ds_read_b64_tr_b16 v[22:23], v19 offset:11520
    s_branch L_rdf
L_candf:
    v_and_b32 v50, 0x70, v4
    v_add_u32 v50, 125696, v50
    ds_read_b128 v[56:59], v50
    s_lshl_b32 s44, s6, 4
    s_add_u32 s44, s44, 8192
    v_mov_b32 v55, s44
L_rdf:

    s_cmp_eq_u32 s3, 7
    s_waitcnt lgkmcnt(0)
    s_cbranch_scc1 L_cand2f
    v_or_b32 v20, s56, v20
    v_or_b32 v21, s57, v21
    v_or_b32 v22, s58, v22
    v_or_b32_e64 v23, s59, v23
    global_store_dwordx4 v49, v[20:23], s[60:61] sc1
    s_branch L_pubf
L_cand2f:
    v_max_f32_dpp v50, v56, v56 row_ror:4 row_mask:0xf bank_mask:0xf
    s_nop 1
    v_max_f32_dpp v50, v50, v50 row_ror:2 row_mask:0xf bank_mask:0xf
    s_nop 1
    v_max_f32_dpp v50, v50, v50 row_ror:1 row_mask:0xf bank_mask:0xf
    v_cmp_eq_u32 vcc, v50, v56
    s_and_b32 exec_lo, vcc_lo, 0xff
    s_mov_b32 exec_hi, 0
    global_store_dwordx4 v55, v[56:59], s[34:35] offset:-4096 sc1
    global_store_dwordx4 v55, v[56:59], s[34:35] sc1
    s_mov_b64 exec, -1
L_pubf:

    s_barrier
L_ffn:
    s_cmp_eq_u32 s3, 7
    s_cbranch_scc1 L_ffn7
    s_cmp_ge_u32 s51, 28
    s_cbranch_scc1 L_spare

    s_nop 0
    global_load_dwordx4 v[136:139], v94, s[26:27] offset:3584
    global_load_dwordx4 v[140:143], v93, s[26:27] offset:-3584
    global_load_dwordx4 v[144:147], v95, s[26:27] offset:-3584
    global_load_dwordx4 v[148:151], v93, s[26:27] offset:3584
    global_load_dwordx4 v[152:155], v95, s[26:27] offset:3584
    global_load_dwordx4 v[156:159], v92, s[28:29] offset:-3584
    global_load_dwordx4 v[160:163], v94, s[28:29] offset:-3584
    global_load_dwordx4 v[164:167], v92, s[28:29] offset:3584
    global_load_dwordx4 v[168:171], v94, s[28:29] offset:3584
    global_load_dwordx4 v[172:175], v93, s[28:29] offset:-3584
    global_load_dwordx4 v[176:179], v95, s[28:29] offset:-3584
    global_load_dwordx4 v[180:183], v93, s[28:29] offset:3584
    global_load_dwordx4 v[184:187], v95, s[28:29] offset:3584
    v_and_b32 v51, 0x70, v4
    s_movk_i32 s44, 896
    v_mad_u32_u24 v102, v96, s44, v51
    s_mul_i32 s44, s51, 57344
    s_lshl_b32 s45, s3, 7
    s_add_u32 s44, s44, s45
    s_add_u32 s44, s44, 2688
    v_add_u32 v102, s44, v102
    v_add_u32 v103, 14336, v102

    v_lshrrev_b32 v50, 3, v2
    v_lshlrev_b32 v50, 6, v50
    v_lshl_add_u32 v50, v3, 4, v50
    v_add_u32_e64 v120, s45, v50
    v_bfe_u32 v50, v2, 2, 1
    v_subrev_u32 v50, 1, v50
    v_lshrrev_b32 v112, 16, v50
    v_lshlrev_b32 v114, 16, v50
    v_not_b32 v50, v50
    v_lshrrev_b32 v113, 16, v50
    v_lshlrev_b32 v115, 16, v50
    v_and_b32_e64 v50, 3, v2
    v_mul_u32_u24 v116, 0x5555, v50
    v_and_b32 v50, 1, v3
    v_lshlrev_b32 v50, 4, v50
    v_lshl_add_u32 v50, v51, 1, v50
    v_lshrrev_b32_e64 v52, 1, v3
    v_lshl_add_u32 v50, v52, 8, v50
    s_lshl_b32 s44, s3, 9
    v_add_u32 v121, s44, v50
    v_lshlrev_b32_e64 v122, 2, v1
    v_lshl_add_u32 v123, v1, 1, s45
    s_lshl_b32 s44, s2, 13
    s_lshl_b32 s45, s3, 8
    s_add_u32 s44, s44, s45
    v_lshrrev_b32 v51, 1, v51
    v_lshl_add_u32 v51, v3, 6, v51
    v_add_u32 v119, s44, v51

    v_mov_b32 v220, 0
    v_mov_b32 v221, 0
    v_mov_b32 v222, 0
    v_mov_b32 v223, 0
    v_mov_b32 v224, 0
    v_mov_b32 v225, 0
    v_mov_b32 v226, 0
    v_mov_b32 v227, 0
    v_mov_b32 v228, 0
    v_mov_b32 v229, 0
    v_mov_b32 v230, 0
    v_mov_b32 v231, 0
    s_waitcnt vmcnt(14)
    ds_read_b64_tr_b16 v[60:61], v19
    ds_read_b64_tr_b16 v[62:63], v19 offset:3840
    ds_read_b64_tr_b16 v[64:65], v19 offset:7680
    ds_read_b64_tr_b16 v[66:67], v19 offset:11520
    v_lshrrev_b32 v52, 1, v0
    v_and_b32 v53, 16, v6
    v_lshlrev_b32 v52, 13, v52
    s_lshl_b32 s44, s6, 5
    v_add3_u32 v253, v52, v53, s44
    v_mov_b32 v53, 1839104
    s_mul_i32 s44, s6, 7168
    s_add_u32 s44, s44, 3584
    v_add_u32_e64 v254, s44, v254
    s_mov_b32 s45, 570434048
    s_movk_i32 s46, 0x3f80
    s_mov_b32 s47, 0x3f800000
    v_lshlrev_b32 v40, 16, v255
    v_add_f32 v40, 1.0, v40
    s_waitcnt lgkmcnt(0)

    v_add_u32 v64, s45, v64
    v_lshlrev_b32 v70, 16, v60
    v_and_b32 v71, s96, v60
    v_add_u32 v65, s45, v65
    v_lshlrev_b32 v72, 16, v61
    v_and_b32 v73, s96, v61
    v_add_u32 v66, s45, v66
    v_lshlrev_b32 v74, 16, v62
    v_and_b32 v75, s96, v62
    v_add_u32 v67, s45, v67
    v_lshlrev_b32 v76, 16, v63
    v_and_b32 v77, s96, v63
    v_lshlrev_b32 v80, 16, v64
    v_and_b32 v81, s96, v64
    v_lshlrev_b32 v82, 16, v65
    v_and_b32 v83, s96, v65
    v_lshlrev_b32 v84, 16, v66
    v_and_b32 v85, s96, v66
    v_lshlrev_b32 v86, 16, v67
    v_and_b32_e64 v87, s96, v67
    v_pk_fma_f32 v[70:71], v[80:81], v[40:41], v[70:71] op_sel_hi:[1,0,1]
    v_pk_fma_f32 v[72:73], v[82:83], v[40:41], v[72:73] op_sel_hi:[1,0,1]
    v_pk_fma_f32 v[74:75], v[84:85], v[40:41], v[74:75] op_sel_hi:[1,0,1]
    v_pk_fma_f32 v[76:77], v[86:87], v[40:41], v[76:77] op_sel_hi:[1,0,1]
    s_nop 0
    s_barrier
    global_load_dwordx4 v[188:191], v102, s[30:31] offset:-2688
    global_load_dwordx4 v[192:195], v103, s[30:31] offset:-2688
    global_load_dwordx4 v[196:199], v102, s[30:31] offset:-896
    global_load_dwordx4 v[200:203], v103, s[30:31] offset:-896
    s_barrier
    ds_read_b128 v[20:23], v120 offset:0
    s_waitcnt vmcnt(4) lgkmcnt(0)
    v_and_b32 v24, v20, v112
    v_and_b32 v25, v20, v113
    v_and_b32 v26, v20, v114
    v_and_b32 v27, v20, v115
    v_and_b32 v28, v21, v112
    v_and_b32 v29, v21, v113
    v_and_b32 v30, v21, v114
    v_and_b32 v31, v21, v115
    v_smfmac_f32_16x16x64_bf16 v[220:223], v[24:27], v[124:131], v116
    v_smfmac_f32_16x16x64_bf16 v[224:227], v[24:27], v[156:163], v116
    v_and_b32 v24, v22, v112
    v_and_b32 v25, v22, v113
    v_and_b32 v26, v22, v114
    v_and_b32 v27, v22, v115
    v_smfmac_f32_16x16x64_bf16 v[220:223], v[28:31], v[132:139], v116
    v_smfmac_f32_16x16x64_bf16 v[224:227], v[28:31], v[164:171], v116
    v_and_b32 v28, v23, v112
    v_and_b32 v29, v23, v113
    v_and_b32 v30, v23, v114
    v_and_b32 v31, v23, v115
    v_smfmac_f32_16x16x64_bf16 v[220:223], v[24:27], v[140:147], v116
    v_smfmac_f32_16x16x64_bf16 v[224:227], v[24:27], v[172:179], v116
    v_smfmac_f32_16x16x64_bf16 v[220:223], v[28:31], v[148:155], v116
    v_smfmac_f32_16x16x64_bf16 v[224:227], v[28:31], v[180:187], v116
    global_load_dwordx4 v[204:207], v102, s[30:31] offset:896
    global_load_dwordx4 v[208:211], v103, s[30:31] offset:896
    global_load_dwordx4 v[212:215], v102, s[30:31] offset:2688
    global_load_dwordx4 v[216:219], v103, s[30:31] offset:2688
    s_mov_b32 s62, 0x00ff00ff
    s_mov_b32 s63, 0x00ff00ff
    s_nop 5
    v_permlane32_swap_b32 v220, v224
    v_permlane32_swap_b32 v221, v225
    v_permlane32_swap_b32 v222, v226
    v_permlane32_swap_b32 v223, v227
    s_nop 0
    v_add_f32_dpp v24, v224, v220 row_shl:8 row_mask:0xf bank_mask:0xf
    v_add_f32_dpp v25, v225, v221 row_shl:8 row_mask:0xf bank_mask:0xf
    v_add_f32_dpp v26, v226, v222 row_shl:8 row_mask:0xf bank_mask:0xf
    v_add_f32_dpp v27, v227, v223 row_shl:8 row_mask:0xf bank_mask:0xf
    s_mov_b64 exec, s[62:63]
    ds_write_b128 v121, v[24:27] offset:2048
    s_mov_b64 exec, -1
    s_waitcnt lgkmcnt(0)
    s_barrier

    ds_read2st64_b32 v[24:25], v122 offset0:8 offset1:9
    ds_read2st64_b32 v[26:27], v122 offset0:10 offset1:11
    ds_read2st64_b32 v[28:29], v122 offset0:12 offset1:13
    ds_read2st64_b32 v[30:31], v122 offset0:14 offset1:15
    ds_read2st64_b32 v[32:33], v122 offset0:16 offset1:17
    ds_read2st64_b32 v[34:35], v122 offset0:18 offset1:19
    ds_read2st64_b32 v[36:37], v122 offset0:20 offset1:21
    s_waitcnt lgkmcnt(3)
    v_pk_add_f32 v[24:25], v[24:25], v[26:27]
    v_pk_add_f32 v[28:29], v[28:29], v[30:31]
    s_waitcnt lgkmcnt(0)
    v_pk_add_f32 v[32:33], v[32:33], v[34:35]
    v_pk_add_f32 v[24:25], v[24:25], v[28:29]
    v_pk_add_f32 v[32:33], v[32:33], v[36:37]
    v_pk_add_f32 v[24:25], v[24:25], v[32:33]
    v_mul_f32 v27, 0xbfb8aa3b, v24
    v_mul_f32 v26, v24, v25
    v_exp_f32 v27, v27
    s_nop 0
    v_add_f32 v27, 1.0, v27
    v_rcp_f32 v27, v27
    s_nop 0
    v_mul_f32_e64 v26, v26, v27
    v_cvt_pk_bf16_f32 v26, v26, v26
    ds_write_b16 v123, v26 offset:8192
    ds_read_b128 v[20:23], v120 offset:8192
    s_waitcnt vmcnt(0) lgkmcnt(0)

    v_and_b32 v24, v20, v112
    v_and_b32 v25, v20, v113
    v_and_b32 v26, v20, v114
    v_and_b32 v27, v20, v115
    v_and_b32 v28, v21, v112
    v_and_b32 v29, v21, v113
    v_and_b32 v30, v21, v114
    v_and_b32_e64 v31, v21, v115
    v_smfmac_f32_16x16x64_bf16 v[228:231], v[24:27], v[188:195], v116
    v_and_b32 v24, v22, v112
    v_and_b32 v25, v22, v113
    v_and_b32 v26, v22, v114
    v_and_b32 v27, v22, v115
    v_smfmac_f32_16x16x64_bf16 v[228:231], v[28:31], v[196:203], v116
    v_and_b32 v28, v23, v112
    v_and_b32 v29, v23, v113
    v_and_b32 v30, v23, v114
    v_and_b32 v31, v23, v115
    v_smfmac_f32_16x16x64_bf16 v[228:231], v[24:27], v[204:211], v116
    s_nop 0
    v_smfmac_f32_16x16x64_bf16 v[228:231], v[28:31], v[212:219], v116
    s_nop 11
    v_permlane32_swap_b32 v228, v230
    v_permlane32_swap_b32 v229, v231
    s_nop 0
    v_add_f32_dpp v24, v230, v228 row_shl:8 row_mask:0xf bank_mask:0xf
    v_add_f32_dpp v25, v231, v229 row_shl:8 row_mask:0xf bank_mask:0xf
    s_mov_b64 exec, s[62:63]
    global_store_dwordx2 v119, v[24:25], s[22:23] sc1
    s_mov_b64 exec, -1

    s_branch L_bar3
L_spare:
    s_waitcnt vmcnt(0)
    s_barrier
    s_branch L_prep
L_ffn7:
    v_add_u32 v50, 4096, v4
    s_not_b32 s47, s39
    s_mov_b32 s50, 0
    s_waitcnt vmcnt(0)
L_poll3:

    global_load_dwordx4 v[20:23], v50, s[34:35] offset:0 sc1
    global_load_dwordx4 v[24:27], v50, s[34:35] offset:1024 sc1
    global_load_dwordx4 v[28:31], v50, s[34:35] offset:2048 sc1
    global_load_dwordx4 v[32:35], v50, s[34:35] offset:3072 sc1
    s_waitcnt vmcnt(0)
    v_xor_b32 v51, s47, v23
    v_bitop3_b32 v51, v51, v27, s47 bitop3:0xf6
    v_bitop3_b32 v51, v51, v31, s47 bitop3:0xf6
    v_bitop3_b32 v51, v51, v35, s47 bitop3:0xf6
    v_cmp_ne_u32 vcc, 0, v51
    s_add_u32 s50, s50, 1
    s_cmp_ge_u32 s50, 200000
    s_cbranch_scc1 L_poll3_done
    s_mov_b64 exec, vcc
    s_cbranch_execnz L_poll3
L_poll3_done:
    s_mov_b64 exec, -1

    v_max3_f32 v51, v20, v24, v28
    v_max_f32 v51, v51, v32
    v_cmp_eq_u32_e64 vcc, v51, v24
    s_nop 0
    v_max_f32_dpp v52, v51, v51 row_ror:8 row_mask:0xf bank_mask:0xf
    v_cmp_eq_u32 s[62:63], v51, v28
    v_cndmask_b32_e64 v21, v21, v25, vcc
    v_max_f32_dpp v52, v52, v52 row_ror:4 row_mask:0xf bank_mask:0xf
    v_cndmask_b32 v22, v22, v26, vcc
    v_cmp_eq_u32 vcc, v51, v32
    v_max_f32_dpp v52, v52, v52 row_ror:2 row_mask:0xf bank_mask:0xf
    v_cndmask_b32 v21, v21, v29, s[62:63]
    v_cndmask_b32 v22, v22, v30, s[62:63]
    v_max_f32_dpp v52, v52, v52 row_ror:1 row_mask:0xf bank_mask:0xf
    v_cndmask_b32 v21, v21, v33, vcc
    v_cndmask_b32 v22, v22, v34, vcc
    v_max_f32_dpp v52, v52, v52 row_bcast:15 row_mask:0xa bank_mask:0xf
    s_nop 1
    v_max_f32_dpp v52, v52, v52 row_bcast:31 row_mask:0xc bank_mask:0xf
    s_nop 0
    v_readlane_b32 s42, v52, 63
    s_and_b32 s49, s42, 0x7ff
    s_cmp_ge_u32 s51, 28
    s_cbranch_scc1 L_spare7
    s_mul_i32 s44, s49, 896
    v_add_u32_e64 v53, s44, v4
    s_mov_b32 exec_hi, 0x00ffffff
    global_load_dwordx4 v[10:13], v53, s[8:9]
    s_mov_b32 exec_hi, -1
    s_barrier
    v_cmp_eq_u32_e64 vcc, s42, v51
    s_ff1_i32_b64 s45, vcc
    s_and_b32 s45, s45, 63
    v_readlane_b32 s46, v21, s45
    v_readlane_b32 s47, v22, s45
    s_waitcnt vmcnt(0)

    v_lshlrev_b32 v20, 16, v10
    v_and_b32 v21, s96, v10
    v_lshlrev_b32 v22, 16, v11
    v_and_b32 v23, s96, v11
    v_lshlrev_b32 v24, 16, v12
    v_and_b32 v25, s96, v12
    v_lshlrev_b32 v26, 16, v13
    v_and_b32_e64 v27, s96, v13
    v_pk_fma_f32 v[20:21], v[20:21], s[46:47], s[46:47] op_sel:[0,0,1] op_sel_hi:[1,0,1]
    v_pk_fma_f32 v[22:23], v[22:23], s[46:47], s[46:47] op_sel:[0,0,1] op_sel_hi:[1,0,1]
    v_pk_fma_f32 v[24:25], v[24:25], s[46:47], s[46:47] op_sel:[0,0,1] op_sel_hi:[1,0,1]
    v_pk_fma_f32 v[26:27], v[26:27], s[46:47], s[46:47] op_sel:[0,0,1] op_sel_hi:[1,0,1]
    v_cvt_pk_bf16_f32 v28, v20, v21
    v_cvt_pk_bf16_f32 v29, v22, v23
    v_cvt_pk_bf16_f32 v30, v24, v25
    v_cvt_pk_bf16_f32 v31, v26, v27
    ds_write_b128 v4, v[28:31] offset:0
    ds_write_b128 v4, v[10:13] offset:1024
    s_waitcnt lgkmcnt(0)
    s_barrier
    s_min_u32 s46, s51, 6
    s_lshl_b32 s45, s46, 7
    v_lshl_add_u32 v51, v1, 1, s45
    global_load_ushort v40, v51, s[20:21]
    ds_read_u16 v41, v51 offset:0
    ds_read_u16 v42, v51 offset:1024
    v_add_u32 v62, s44, v51
    v_lshrrev_b32 v52, 2, v51
    v_and_b32_e64 v50, 16, v4
    v_lshl_add_u32 v52, v52, 13, v50
    s_lshr_b32 s45, s49, 3
    s_lshl_b32 s45, s45, 5
    s_and_b32 s47, s49, 6
    s_lshl1_add_u32 s45, s47, s45
    v_add_u32_e64 v52, s45, v52
    v_bfe_u32 v50, v1, 2, 1
    v_and_b32 v54, 2, v1
    v_add_u32 v50, v50, v54
    v_lshlrev_b32 v50, 6, v50
    v_and_b32 v54, 0x38, v1
    v_add_u32 v50, v50, v54
    v_and_b32 v54, 1, v1
    v_lshl_add_u32 v50, v54, 2, v50
    s_lshl_b32 s46, s46, 8
    s_add_u32 s46, s46, 1835008
    v_add_u32_e64 v100, s46, v50
    s_barrier

    v_add_u32 v101, 8192, v100
    v_add_u32 v102, 16384, v100
    v_add_u32 v103, 24576, v100
    v_add_u32 v104, 32768, v100
    v_add_u32 v105, 40960, v100
    v_add_u32 v106, 49152, v100
    v_add_u32 v107, 57344, v100
    v_add_u32 v108, 65536, v100
    v_add_u32 v109, 73728, v100
    v_add_u32 v110, 81920, v100
    v_add_u32 v111, 90112, v100
    v_add_u32 v112, 98304, v100
    v_add_u32 v113, 106496, v100
    v_add_u32 v114, 114688, v100
    v_add_u32 v115, 122880, v100
    v_add_u32 v116, 131072, v100
    v_add_u32 v117, 139264, v100
    v_add_u32 v118, 147456, v100
    v_add_u32 v119, 155648, v100
    v_add_u32 v120, 163840, v100
    v_add_u32 v121, 172032, v100
    v_add_u32 v122, 180224, v100
    v_add_u32 v123, 188416, v100
    v_add_u32 v124, 196608, v100
    v_add_u32 v125, 204800, v100
    v_add_u32 v126, 212992, v100
    v_add_u32 v127, 221184, v100
    s_and_b32 s45, s42, s96
    v_mov_b32 v43, s45
    v_mul_f32 v43, 0xbfb8aa3b, v43
    v_exp_f32 v43, v43
    s_nop 0
    v_add_f32 v43, 1.0, v43
    v_rcp_f32 v43, v43
    s_waitcnt vmcnt(0) lgkmcnt(0)
    v_lshlrev_b32 v40, 16, v40
    v_lshlrev_b32 v41, 16, v41
    v_lshlrev_b32 v42, 16, v42
    v_add_f32 v40, 1.0, v40
    v_fmac_f32 v42, v40, v41
    s_bitcmp1_b32 s49, 0
    s_cselect_b32 s45, 16, 0
    s_lshl_b32 s45, 0x3f80, s45
    v_mov_b32 v53, 1839104
    s_mov_b32 s50, 0
L_pif:
    global_load_dword v24, v53, s[22:23] sc1
    s_add_u32 s50, s50, 1
    s_waitcnt vmcnt(0)
    v_cmp_eq_u32 vcc, -1, v24
    s_cmp_ge_u32 s50, 200000
    s_cbranch_scc1 L_pidf
    s_cbranch_vccnz L_pif
L_pidf:
    s_mov_b32 s50, 0
    s_cmp_ge_u32 s51, 7
    s_barrier
    s_cbranch_scc1 L_fin
L_poll4:

    global_load_dword v130, v100, s[22:23] sc1
    global_load_dword v131, v101, s[22:23] sc1
    global_load_dword v132, v102, s[22:23] sc1
    global_load_dword v133, v103, s[22:23] sc1
    global_load_dword v134, v104, s[22:23] sc1
    global_load_dword v135, v105, s[22:23] sc1
    global_load_dword v136, v106, s[22:23] sc1
    global_load_dword v137, v107, s[22:23] sc1
    global_load_dword v138, v108, s[22:23] sc1
    global_load_dword v139, v109, s[22:23] sc1
    global_load_dword v140, v110, s[22:23] sc1
    global_load_dword v141, v111, s[22:23] sc1
    global_load_dword v142, v112, s[22:23] sc1
    global_load_dword v143, v113, s[22:23] sc1
    global_load_dword v144, v114, s[22:23] sc1
    global_load_dword v145, v115, s[22:23] sc1
    global_load_dword v146, v116, s[22:23] sc1
    global_load_dword v147, v117, s[22:23] sc1
    global_load_dword v148, v118, s[22:23] sc1
    global_load_dword v149, v119, s[22:23] sc1
    global_load_dword v150, v120, s[22:23] sc1
    global_load_dword v151, v121, s[22:23] sc1
    global_load_dword v152, v122, s[22:23] sc1
    global_load_dword v153, v123, s[22:23] sc1
    global_load_dword v154, v124, s[22:23] sc1
    global_load_dword v155, v125, s[22:23] sc1
    global_load_dword v156, v126, s[22:23] sc1
    global_load_dword v157, v127, s[22:23] sc1
    global_load_dword v27, v52, s[22:23] sc1
    s_waitcnt vmcnt(1)
    v_max_u32 v28, v130, v131
    v_max3_u32 v28, v28, v132, v133
    v_max3_u32 v28, v28, v134, v135
    v_max3_u32 v28, v28, v136, v137
    v_max3_u32 v28, v28, v138, v139
    v_max3_u32 v28, v28, v140, v141
    v_max3_u32 v28, v28, v142, v143
    v_max3_u32 v28, v28, v144, v145
    v_max3_u32 v28, v28, v146, v147
    v_max3_u32 v28, v28, v148, v149
    v_max3_u32 v28, v28, v150, v151
    v_max3_u32 v28, v28, v152, v153
    v_max3_u32 v28, v28, v154, v155
    v_max3_u32 v28, v28, v156, v157
    v_cmp_eq_u32 vcc, -1, v28
    s_add_u32 s50, s50, 1
    s_cmp_ge_u32 s50, 200000
    s_cbranch_scc1 L_poll4_done
    s_cbranch_vccnz L_poll4
L_poll4_done:

    v_pk_add_f32 v[130:131], v[130:131], v[156:157]
    v_pk_add_f32 v[132:133], v[132:133], v[154:155]
    v_pk_add_f32 v[134:135], v[134:135], v[152:153]
    v_pk_add_f32 v[136:137], v[136:137], v[150:151]
    v_pk_add_f32 v[138:139], v[138:139], v[148:149]
    v_pk_add_f32 v[140:141], v[140:141], v[146:147]
    v_pk_add_f32 v[142:143], v[142:143], v[144:145]
    v_pk_add_f32 v[130:131], v[130:131], v[142:143]
    v_pk_add_f32 v[132:133], v[132:133], v[140:141]
    v_pk_add_f32 v[134:135], v[134:135], v[138:139]
    v_pk_add_f32 v[130:131], v[130:131], v[136:137]
    v_pk_add_f32 v[132:133], v[132:133], v[134:135]
    v_pk_add_f32 v[130:131], v[130:131], v[132:133]
    v_add_f32 v130, v130, v131
    v_fmac_f32 v42, v130, v43
    s_mov_b32 s50, 0
L_poll6:
    s_waitcnt vmcnt(0)
    v_cmp_eq_u32_e64 vcc, -1, v27
    s_add_u32 s50, s50, 1
    s_cbranch_vccz L_poll6_done
    s_cmp_ge_u32 s50, 200000
    s_cbranch_scc1 L_poll6_done
    s_mov_b64 exec, vcc
    global_load_dword v27, v52, s[22:23] sc1
    s_branch L_poll6
L_poll6_done:
    s_mov_b64 exec, -1

    v_dot2c_f32_bf16 v42, s45, v27
    s_nop 2
    v_cvt_pk_bf16_f32 v20, v42, v42
    global_store_short v62, v20, s[32:33] sc1
    s_endpgm
L_spare7:
    s_barrier
    v_mov_b32 v53, 1839104
    s_cmp_lg_u32 s51, 28
    s_cbranch_scc1 L_sp2
    v_add_u32 v50, 4108, v50
    s_mov_b32 s50, 0
L_poll5:
    s_nop 0
    global_load_dword v20, v50, s[34:35] sc1
    global_load_dword v21, v50, s[34:35] offset:1024 sc1
    global_load_dword v22, v50, s[34:35] offset:2048 sc1
    global_load_dword v23, v50, s[34:35] offset:3072 sc1
    s_waitcnt vmcnt(0)
    v_xor_b32 v51, s47, v20
    v_bitop3_b32 v51, v51, v21, s47 bitop3:0xf6
    v_bitop3_b32 v51, v51, v22, s47 bitop3:0xf6
    v_bitop3_b32 v51, v51, v23, s47 bitop3:0xf6
    v_cmp_ne_u32 vcc, 0, v51
    s_add_u32 s50, s50, 1
    s_cmp_ge_u32 s50, 200000
    s_cbranch_scc1 L_poll5_done
    s_mov_b64 exec, vcc
    s_cbranch_execnz L_poll5
L_poll5_done:
    s_mov_b64 exec, 1
    v_mov_b32_e64 v54, s49
    global_store_dword v53, v54, s[22:23] sc1
    s_mov_b64 exec, -1
L_sp2:
    s_mov_b32 s50, 0
L_pis:
    global_load_dword v24, v53, s[22:23] sc1
    s_add_u32 s50, s50, 1
    s_waitcnt vmcnt(0)
    v_cmp_eq_u32_e64 vcc, -1, v24
    s_cmp_ge_u32 s50, 200000
    s_cbranch_scc1 L_pids
    s_cbranch_vccnz L_pis
L_pids:
    s_barrier
L_fin:

L_end:
    s_endpgm

.p2align 7
.type addr_tab,@object
addr_tab:
.long 8651448,17039556,545262620,16384,8781824,17170630,546308956,3612360720,8912968,17301704,547359768,41959456,9044042,17432778,548406104,3654303792
.long 9175116,17563852,549456916,1065024,9306190,17694926,550503252,3613409360,9437264,17826000,551554064,43008096,9568338,17957074,552600400,3655352432
.long 9699412,18088148,553651212,2113664,9830486,18219222,554697548,3614458000,9961560,18350296,555748360,44056736,10092634,18481370,556794696,3656401072
.long 10223708,18612444,557845508,3162304,10354782,18743518,558891844,3615506640,10485856,18874592,559942656,45105376,10616930,19005666,560988992,3657449712
.long 10748004,19136740,613420076,4210944,10879078,19267814,614466412,3616555280,11010152,19398888,615517224,46154016,11141226,19529962,616563560,3658498352
.long 11272300,19661036,617614372,5259584,11403374,19792110,618660708,3617603920,11534448,19923184,619711520,47202656,11665522,20054258,620757856,3659546992
.long 11796596,20185332,621808668,6308224,11927670,20316406,622855004,3618652560,12058744,20447480,623905816,48251296,12189818,20578554,624952152,3660595632
.long 12320892,20709628,626002964,7356864,12451966,20840702,627049300,3619701200,12583040,20971776,628100112,49299936,12714114,21102850,629146448,3661644272
.long 324,0,681577532,8405632,888,0,545260412,3620749968,3126,0,545262648,33571488,886,0,545260408,3645915824
.long 3124,0,545262644,9454272,884,0,546308980,3621798608,3122,0,546311216,34620128,882,0,546308976,3646964464
.long 3120,0,546311212,10502656,880,0,546308972,3622846992,3118,0,546311208,35668512,878,0,546308968,3648012848
.long 3116,0,546311204,11551296,876,0,546308964,3623895632,3114,0,546311200,36717152,874,0,546308960,3649061488
.long 3112,0,546311244,12600192,872,0,546309004,3624944528,3110,0,546311240,37766048,0,0,904,3650110384
.long 0,0,3140,13648832,0,0,900,3625993168,0,0,3136,38814688,0,0,896,3651159024
.long 0,0,3132,14697216,0,0,892,3627041552,0,0,3128,39863072,0,0,888,3652207408
.long 0,0,3124,15745856,0,0,884,3628090192,0,0,3120,40911712,0,0,880,3653256048
.long 0,37356088,408947740,67133440,0,37618236,409994076,3679477776,29491648,37880384,411044888,109076512,29753796,38142532,412091224,3721420848
.long 30015944,38404680,413142036,68182080,30278092,38666828,414188372,3680526416,30540240,38928976,415239184,110125152,30802388,39191124,416285520,3722469488
.long 31064536,39453272,417336332,69230720,31326684,39715420,418382668,3681575056,31588832,39977568,419433480,111173792,31850980,40239716,420479816,3723518128
.long 32113128,40501864,421530628,70279360,32375276,40764012,422576964,3682623696,32637424,41026160,423627776,112222432,32899572,41288308,424674112,3724566768
.long 33161720,41550456,477105196,71328000,33423868,41812604,478151532,3683672336,33686016,42074752,479202344,113271072,33948164,42336900,480248680,3725615408
.long 34210312,42599048,481299492,72376640,34472460,42861196,482345828,3684720976,34734608,43123344,483396640,114319712,34996756,43385492,484442976,3726664048
.long 35258904,43647640,485493788,73425280,35521052,43909788,486540124,3685769616,35783200,44171936,487590936,115368352,36045348,44434084,488637272,3727712688
.long 36307496,44696232,489688084,74473920,36569644,44958380,490734420,3686818256,36831792,45220528,491785232,116416992,37093940,45482676,492831568,3728761328
.long 125306752,0,408947772,75522688,125175678,0,408945532,3687867024,125044604,0,408947768,100688544,1914,0,408945528,3713032880
.long 271978558,0,408947764,76571328,271847484,0,408945524,3688915664,271716410,0,408947760,101737184,4152,0,408945520,3714081520
.long 124258162,0,409996332,77619712,124127088,0,409994092,3689964048,123996014,0,409996328,102785568,1900,0,409994088,3715129904
.long 1898,0,409996324,78668352,270929968,0,409994084,3691012688,270798894,0,409996320,103834208,270667820,0,409994080,3716178544
.long 4138,0,409996364,79717248,4136,0,409994124,3692061584,0,0,3144,104883104,0,0,904,3717227440
.long 0,0,3140,80765888,0,0,900,3693110224,0,0,3136,105931744,0,0,896,3718276080
.long 0,0,3132,81814272,0,0,892,3694158608,0,0,3128,106980128,0,0,888,3719324464
.long 0,0,3124,82862912,0,0,884,3695207248,0,0,3120,108028768,0,0,880,3720373104
.long 4664,305924474,272629760,268435456,305402416,158861682,272629776,3880779776,304878120,158337386,273678368,310378496,304353824,157813090,273678384,3922722816
.long 303829528,157288794,274726976,269484032,303305232,156764498,274727232,3881828352,302780936,156240202,275775824,311427072,302256640,155715906,275775840,3923771392
.long 301732344,155191610,276824432,270532608,301208048,154667314,276824448,3882876928,300683752,154143018,277873040,312475648,300159456,153618722,277873056,3924819968
.long 299635160,153094426,278921648,271581184,299110864,152570130,278921904,3883925504,298586568,152045834,279970496,313524224,298062272,151521538,279970512,3925868544
.long 297537976,150997242,281019104,272629760,297013680,150472946,281019120,3884974080,296489384,149948650,282067712,314572800,295965088,149424354,282067728,3926917120
.long 295440792,148900058,283116320,273678336,294916496,148375762,283116336,3886022656,294392200,147851466,284164928,315621376,293867904,147327170,284164944,3927965696
.long 293343608,146802874,285213536,274726912,292819312,146278578,285213552,3887071232,292295016,145754282,286262144,316669952,291770720,145229986,286262160,3929014272
.long 291246424,144705690,287311664,275775488,290722128,144181394,287311680,3888119808,290197832,143657098,288360272,317718528,289673536,143132802,288360288,3930062848
.long 289149240,142608506,340790128,276824064,288624944,142084210,340790144,3889168384,288100648,141559914,341838736,301989888,287576352,141035618,341838848,3914334208
.long 287052056,140511322,342887440,277872640,286527760,139987026,342887456,3890216960,286003464,139462730,343936048,303038464,285479168,138938434,343936064,3915382784
.long 284954872,138414138,344984656,278921216,284430576,137889842,344985584,3891265536,283906280,137365546,346034176,304087040,283381984,136841250,346034192,3916431360
.long 282857688,136316954,347082784,279969792,282333392,135792658,347083824,3892314112,281809096,135268362,348132416,305135616,281284800,134744066,348132432,3917479936
.long 280760504,134219770,349181120,281018368,280236208,133695474,349181136,3893362688,279711912,133171178,350229728,306184192,279187616,132646882,350229744,3918528512
.long 278663320,132122586,351278336,282066944,278139024,131598290,351278352,3894411264,277614728,131073994,352326944,307232768,277090432,130549698,352326960,3919577088
.long 276566136,130025402,353375552,283115520,276041840,129501106,353375568,3895459840,275517544,128976810,354424160,308281344,274993248,128452514,354424176,3920625664
.long 274468952,127928218,355472768,284164096,273944656,127403922,355472784,3896508416,273420360,126879626,356521376,309329920,272896064,126355330,356521392,3921674240
.long 192678776,339481654,5568,335544320,192154480,338957358,136320464,3947888640,191630184,338433062,1054176,377487360,191105888,337908766,137369072,3989831680
.long 190581592,337384470,2102784,336592896,190057296,336860174,138417680,3948937216,189533000,336335878,3151392,378535936,189008704,335811582,139466288,3990880256
.long 188484408,335287286,4200000,337641472,187960112,334762990,140514896,3949985792,187435816,334238694,5248608,379584512,186911520,333714398,141563504,3991928832
.long 186387224,333190102,6297216,338690048,185862928,332665806,142612112,3951034368,185338632,332141510,7345808,380633088,184814336,331617214,143660688,3992977408
.long 184290040,331092918,8394384,339738624,183765744,330568622,144709264,3952082944,183241448,330044326,9442960,381681664,182717152,329520030,145757840,3994025984
.long 182192856,328995734,10491536,340787200,181668560,328471438,146806416,3953131520,181144264,327947142,11540112,382730240,180619968,327422846,147854992,3995074560
.long 180095672,326898550,12588688,341835776,179571376,326374254,148903568,3954180096,179047080,325849958,13637264,383778816,178522784,325325662,149952144,3996123136
.long 177998488,324801366,14685840,342884352,177474192,324277070,151000720,3955228672,176949896,323752774,15734416,384827392,176425600,323228478,152049296,3997171712
.long 175901304,322704182,68163216,343932928,175377008,322179886,204478096,3956277248,174852712,321655590,69211792,369098752,174328416,321131294,205526672,3981443072
.long 173804120,320606998,70260368,344981504,173279824,320082702,206575248,3957325824,172755528,319558406,71308944,370147328,172231232,319034110,207623824,3982491648
.long 171706936,318509814,72357520,346030080,171182640,317985518,208672400,3958374400,170658344,317461222,73406096,371195904,170134048,316936926,209720976,3983540224
.long 169609752,316412630,74454672,347078656,169085456,315888334,210769552,3959422976,168561160,315364038,75503248,372244480,168036864,314839742,211818128,3984588800
.long 167512568,314315446,76551824,348127232,166988272,313791150,212866704,3960471552,166463976,313266854,77600400,373293056,165939680,312742558,213915280,3985637376
.long 165415384,312218262,78648976,349175808,164891088,311693966,214963856,3961520128,164366792,311169670,79697552,374341632,163842496,310645374,216012432,3986685952
.long 163318200,310121078,80746128,350224384,162793904,309596782,217061008,3962568704,162269608,309072486,81794704,375390208,161745312,308548190,218109584,3987734528
.long 161221016,308023894,82843280,351272960,160696720,307499598,219158160,3963617280,160172424,306975302,83891856,376438784,159648128,306451006,220206736,3988783104
.long 15728864,6815816,14680288,4718784,14680256,12583040,12583104,8388736,12583040,8388608,8388736,0,8388608,0,0,0
.long 0,0,0,0,0,0,0,0,0,0,0,0,0,0,0,0
.long 983055,65539,983070,196611,1966110,196615,1966140,458774,3932220,1441822,3932280,1966140,7864440,3932204,7864560,2883688
.long 15728864,6815816,14680288,4718784,14680256,12583040,12583104,8388736,12583040,8388608,8388736,0,8388608,0,0,0
.long 1,0,65537,0,65539,0,196611,0,196615,0,458759,0,458767,1,983055,65537
.long 983055,65539,983070,196611,1966110,196615,1966140,458774,3932220,1441822,3932280,1966140,7864440,3932204,7864560,2883688
.long 0,0,0,0,0,0,0,0,0,0,0,0,0,0,0,0
.long 1,0,65537,0,65539,0,196611,0,196615,0,458759,0,458767,1,983055,65537
.long 15728864,6815816,14680288,4718784,14680256,12583040,12583104,8388736,12583040,8388608,8388736,0,8388608,0,0,0
.long 0,0,0,0,0,0,0,0,0,0,0,0,0,0,0,0
.long 983055,65539,983070,196611,1966110,196615,1966140,458774,3932220,1441822,3932280,1966140,7864440,3932204,7864560,2883688
.long 15728864,6815816,14680288,4718784,14680256,12583040,12583104,8388736,12583040,8388608,8388736,0,8388608,0,0,0
.long 1,0,65537,0,65539,0,196611,0,196615,0,458759,0,458767,1,983055,65537
.long 983055,65539,983070,196611,1966110,196615,1966140,458774,3932220,1441822,3932280,1966140,7864440,3932204,7864560,2883688
.long 0,0,0,0,0,0,0,0,0,0,0,0,0,0,0,0
.long 1,0,65537,0,65539,0,196611,0,196615,0,458759,0,458767,1,983055,65537
.long 16777986,16777472,84150022,84149508,16777986,16777472,84150022,84149508,16777986,16777472,84150022,84149508,16777986,16777472,84150022,84149508
.long 16777986,16777472,84150022,84149508,16777986,16777472,84150022,84149508,16777986,16777472,84150022,84149508,16777986,16777472,84150022,84149508
.long 16777986,16777472,84150022,84149508,16777986,16777472,84150022,84149508,16777986,16777472,84150022,84149508,16777986,16777472,84150022,84149508
.long 16777986,16777472,84150022,84149508,16777986,16777472,84150022,84149508,16777986,16777472,84150022,84149508,16777986,16777472,84150022,84149508
.long 16777986,16777472,84150022,84149508,16777986,16777472,84150022,84149508,16777986,16777472,84150022,84149508,16777986,16777472,84150022,84149508
.long 16777986,16777472,84150022,84149508,16777986,16777472,84150022,84149508,16777986,16777472,84150022,84149508,16777986,16777472,84150022,84149508
.long 16777986,16777472,84150022,84149508,16777986,16777472,84150022,84149508,16777986,16777472,84150022,84149508,16777986,16777472,84150022,84149508
.long 16777986,16777472,84150022,84149508,16777986,16777472,84150022,84149508,16777986,16777472,84150022,84149508,16777986,16777472,84150022,84149508
.long 84150022,16777986,84150022,16777986,84150022,16777986,84150022,16777986,84150022,16777986,84150022,16777986,84150022,16777986,84150022,16777986
.long 84150022,16777986,84150022,16777986,84150022,16777986,84150022,16777986,84150022,16777986,84150022,16777986,84150022,16777986,84150022,16777986
.long 84150022,16777986,84150022,16777986,84150022,16777986,84150022,16777986,84150022,16777986,84150022,16777986,84150022,16777986,84150022,16777986
.long 84150022,16777986,84150022,16777986,84150022,16777986,84150022,16777986,84150022,16777986,84150022,16777986,84150022,16777986,84150022,16777986
.long 84150022,16777986,84150022,16777986,84150022,16777986,84150022,16777986,84150022,16777986,84150022,16777986,84150022,16777986,84150022,16777986
.long 84150022,16777986,84150022,16777986,84150022,16777986,84150022,16777986,84150022,16777986,84150022,16777986,84150022,16777986,84150022,16777986
.long 84150022,16777986,84150022,16777986,84150022,16777986,84150022,16777986,84150022,16777986,84150022,16777986,84150022,16777986,84150022,16777986
.long 84150022,16777986,84150022,16777986,84150022,16777986,84150022,16777986,84150022,16777986,84150022,16777986,84150022,16777986,84150022,16777986
.size addr_tab, 6144
L_code_end:
.section .rodata,"a"
.p2align 6
.amdhsa_kernel parallel_sum__ssm_conv_s4d__moe_arch_mod__prompt_kernel
  .amdhsa_next_free_vgpr 256
  .amdhsa_next_free_sgpr 102
  .amdhsa_accum_offset 256
  .amdhsa_group_segment_fixed_size 0
  .amdhsa_kernarg_size 120
  .amdhsa_user_sgpr_count 2
  .amdhsa_user_sgpr_kernarg_segment_ptr 1
  .amdhsa_system_sgpr_workgroup_id_x 1
  .amdhsa_float_denorm_mode_32 3
.end_amdhsa_kernel
```
